```python
import torch

def _softmax(x, axis=-1):
    return torch.softmax(x, dim=axis)
def _gelu(x):
    return torch.nn.functional.gelu(x, approximate="tanh")
def _silu(x):
    return torch.nn.functional.silu(x)
def _sigmoid(x):
    return torch.sigmoid(x)
def _layernorm(x, axis=-1, eps=1e-5):
    m = x.mean(dim=axis, keepdim=True)
    v = x.var(dim=axis, keepdim=True, unbiased=False)
    return (x - m) / torch.sqrt(v + eps)
def _scatter_add(tgt, idx, src, axis=0):
    return tgt.clone().index_add_(axis, idx, src)
def _segment_sum(src, seg, n):
    out = torch.zeros((n,) + src.shape[1:], dtype=src.dtype)
    return out.index_add_(0, seg, src)
def _pad(x, pw):
    flat = tuple(v for pair in reversed(pw) for v in pair)
    return torch.nn.functional.pad(x, flat)

kernel_name = 'recurrent_scan__sliding_block_cached__glu_gated_glu__decode'

def setup_inputs():

    _w = (lambda a: (lambda t: t.to(torch.bfloat16) if t.is_floating_point() else t)(torch.as_tensor(a)))
    def _A_setup():
        B, Sq, D = 8, 1, 512
        Hq, Hkv, Sk, Dh = 32, 8, 8192, 128
        assert Hq % Hkv == 0, (Hq, Hkv)
        return {
            "x": _w((lambda *s: torch.randn(*s, dtype=torch.bfloat16) * 0.05)(B, Sq, D)),
            "k_cache": _w((lambda *s: torch.randn(*s, dtype=torch.bfloat16) * 1.6)(B, Hkv, Sk, Dh)),
            "v_cache": _w((lambda *s: torch.randn(*s, dtype=torch.bfloat16) * 0.2)(B, Hkv, Sk, Dh)),
            "wq": _w((lambda *s: torch.randn(*s, dtype=torch.bfloat16) * 1.6)(D, Hq * Dh) * (D ** -0.5)),
            "wo": _w((lambda *s: torch.randn(*s, dtype=torch.bfloat16) * 0.2)(Hq * Dh, D) * ((Hq * Dh) ** -0.5)),
        }
    _A_in = _A_setup()

    def _B_setup():
        B, S, D, F = 8, 1, 512, 1792
        return {
            "x": _w((lambda *s: torch.randn(*s, dtype=torch.bfloat16) * 0.05)(B, S, D)),
            "w_gate": _w((lambda *s: torch.randn(*s, dtype=torch.bfloat16) * 0.2)(D, F)),
            "w_up": _w((lambda *s: torch.randn(*s, dtype=torch.bfloat16) * 0.1)(D, F)),
            "w_down": _w((lambda *s: torch.randn(*s, dtype=torch.bfloat16) * 0.1)(F, D)),
        }
    _B_in = _B_setup()

    return {
        "A_x": _A_in["x"],
        "A_k_cache": _A_in["k_cache"],
        "A_v_cache": _A_in["v_cache"],
        "A_wq": _A_in["wq"],
        "A_wo": _A_in["wo"],
        "B_x": _B_in["x"],
        "B_w_gate": _B_in["w_gate"],
        "B_w_up": _B_in["w_up"],
        "B_w_down": _B_in["w_down"],
    }

def reference(A_x, A_k_cache, A_v_cache, A_wq, A_wo, B_x, B_w_gate, B_w_up, B_w_down):
    def _A_ref(x, k_cache, v_cache, wq, wo):
        B, Sq, D = x.shape
        Hq, Dh = 32, 128
        Hkv, Sk = k_cache.shape[1], k_cache.shape[2]
        W = min(4096, max(256, Sk // 4))
        rep = Hq // Hkv
        q = (lambda x, *d: x.permute(*d))((x @ wq).reshape(B, Sq, Hq, Dh), 0, 2, 1, 3)
        k = (lambda x, n, axis: torch.repeat_interleave(x, n, dim=axis))(k_cache[:, :, Sk - W:, :], rep, axis=1)
        v = (lambda x, n, axis: torch.repeat_interleave(x, n, dim=axis))(v_cache[:, :, Sk - W:, :], rep, axis=1)
        scores = torch.einsum("bhqd,bhkd->bhqk", q, k) * (Dh ** -0.5)
        p = _softmax(scores, axis=-1)
        o = torch.einsum("bhqk,bhkd->bhqd", p, v)
        return (lambda x, *d: x.permute(*d))(o, 0, 2, 1, 3).reshape(B, Sq, Hq * Dh) @ wo

    def _B_ref(x, w_gate, w_up, w_down):
        g = torch.einsum("bsd,df->bsf", x, w_gate)
        u = torch.einsum("bsd,df->bsf", x, w_up)
        h = _sigmoid(g) * u
        return torch.einsum("bsf,fd->bsd", h, w_down)

    x = A_x
    xn = _layernorm(x, axis=-1)
    s = _A_ref(xn, A_k_cache, A_v_cache, A_wq, A_wo)
    g = _silu(_B_ref(xn, B_w_gate, B_w_up, B_w_down))
    return x + s * g
```

```asm
; @launch grid=(256,1,1) block=(512,1,1) lds=96256
.amdgcn_target "amdgcn-amd-amdhsa--gfx950"
.text
.globl recurrent_scan__sliding_block_cached__glu_gated_glu__decode_kernel
.p2align 8
.type recurrent_scan__sliding_block_cached__glu_gated_glu__decode_kernel,@function
recurrent_scan__sliding_block_cached__glu_gated_glu__decode_kernel:
  s_cmp_ge_u32 s2, 256
  s_cbranch_scc1 L_end
  s_load_dwordx2 s[64:65], s[0:1], 0
  s_load_dwordx2 s[52:53], s[0:1], 24
  s_load_dwordx4 s[36:39], s[0:1], 48
  s_load_dwordx2 s[40:41], s[0:1], 8
  v_lshrrev_b32 v2, 6, v0
  v_and_b32 v1, 63, v0
  s_and_b32 s4, s2, 7
  v_readfirstlane_b32 s8, v2
  s_lshr_b32 s5, s2, 3
  v_lshrrev_b32 v3, 4, v1
  v_and_b32 v11, 7, v1
  s_and_b32 s9, s8, 3
  s_cmp_ge_u32 s8, 4
  s_cbranch_scc1 L_kwave
  s_setprio 3
  s_lshr_b32 s17, s5, 1
  s_lshl_b32 s13, s4, 3
  s_add_u32 s13, s13, s17
  s_lshl_b32 s18, s4, 2
  s_and_b32 s17, s17, 3
  s_add_u32 s18, s18, s17
  s_and_b32 s15, s5, 1
  s_mov_b32 s14, 3584
  s_mov_b32 s54, 1835008
  s_cmp_ge_u32 s5, 24
  s_cselect_b32 s12, 3, 2
  s_cmp_eq_u32 s4, 7
  s_cselect_b32 s12, 0, s12
  s_cmp_lt_u32 s5, 16
  s_cselect_b32 s12, 1, s12
  s_cselect_b32 s13, s13, s18
  s_cselect_b32 s14, 8192, s14
  s_cselect_b32 s54, 4194304, s54
  s_mov_b32 s55, 0x20000
  s_mov_b32 s66, 8192
  s_mov_b32 s67, 0x20000
  v_lshlrev_b32 v8, 5, v1
  v_lshrrev_b32 v9, 3, v1
  v_mul_lo_u32 v9, v9, s14
  v_lshlrev_b32 v10, 1, v3
  v_xor_b32 v10, v10, v11
  v_lshl_add_u32 v9, v10, 4, v9
  s_lshl_b32 s16, s9, 11
  s_lshl_b32 s17, s15, 2
  s_add_u32 s17, s17, s9
  s_lshl_b32 s18, s14, 6
  s_mul_i32 s17, s17, s18
  s_lshl_b32 s18, s13, 7
  s_add_u32 s17, s17, s18
  s_lshl_b32 s18, s14, 3
  s_lshl_b32 s19, s9, 13
  s_add_u32 s19, s19, 63488
  s_add_u32 s25, s19, 8192
  s_cmp_eq_u32 s12, 0
  s_cbranch_scc1 L_a2
  s_cmp_eq_u32 s12, 3
  s_waitcnt lgkmcnt(0)
  s_cselect_b64 s[36:37], s[38:39], s[36:37]
  buffer_load_dwordx4 v[64:67], v8, s[64:67], s16 offen
  buffer_load_dwordx4 v[68:71], v8, s[64:67], s16 offen offset:16
  s_cmp_eq_u32 s12, 1
  s_cselect_b64 s[52:53], s[52:53], s[36:37]
L_udma:
  s_mov_b32 m0, s19
  s_add_u32 s19, s19, 1024
  buffer_load_dwordx4 v9, s[52:55], s17 offen nt lds
  s_add_u32 s17, s17, s18
  s_cmp_lt_u32 s19, s25
  s_cbranch_scc1 L_udma
  s_branch L_a2
L_kwave:
  s_setprio 2
  s_lshr_b32 s6, s5, 2
  s_and_b32 s7, s5, 3
  s_lshl_b32 s20, s7, 5
  s_add_u32 s20, s20, s9
  s_lshl_b32 s20, s20, 12
  s_lshl_b32 s16, s6, 3
  s_add_u32 s16, s16, s4
  s_lshl_b32 s16, s16, 21
  s_add_u32 s20, s20, s16
  s_add_u32 s20, s20, 1572864
  s_mov_b32 s42, 0x8000000
  s_mov_b32 s43, 0x20000
  v_lshlrev_b32 v4, 8, v11
  v_bfe_u32 v6, v1, 3, 1
  v_lshl_add_u32 v4, v6, 6, v4
  v_lshl_add_u32 v4, v3, 4, v4
  s_waitcnt lgkmcnt(0)
  buffer_load_dwordx4 v[64:67], v4, s[40:43], s20 offen offset:0 nt
  buffer_load_dwordx4 v[68:71], v4, s[40:43], s20 offen offset:128 nt
  buffer_load_dwordx4 v[72:75], v4, s[40:43], s20 offen offset:2048 nt
  buffer_load_dwordx4 v[76:79], v4, s[40:43], s20 offen offset:2176 nt
  s_load_dwordx2 s[48:49], s[0:1], 88
  s_mov_b32 s50, 8388608
  s_mov_b32 s51, 0x20000
  s_mov_b32 s82, 2000000
  s_lshl_b32 s76, s4, 2
  s_lshr_b32 s16, s5, 3
  s_add_u32 s76, s76, s16
  v_and_b32 v2, 15, v1
  v_mov_b32 v7, 0
  v_lshlrev_b32 v16, 4, v1
  v_mov_b32 v19, 1
  s_mov_b32 s80, 0xff00ff00
  s_mov_b32 s81, 0xff00ff00
  s_getpc_b64 s[22:23]
L_pc:
  s_sub_u32 s22, s22, L_pc-recurrent_scan__sliding_block_cached__glu_gated_glu__decode_kernel
  s_subb_u32 s23, s23, 0
  s_mul_i32 s16, s5, 416
  v_add_u32 v6, s16, v16
  v_cmp_gt_u32 vcc, L_end-recurrent_scan__sliding_block_cached__glu_gated_glu__decode_kernel-12, v6
  s_cmp_eq_u32 s9, 3
  s_cselect_b32 s16, 0x3ffffff, 0
  s_and_b32 exec_lo, vcc_lo, s16
  s_mov_b32 exec_hi, 0
  global_load_dwordx4 v[60:63], v6, s[22:23]
  s_mov_b64 exec, -1
  s_load_dwordx2 s[56:57], s[0:1], 32
  s_load_dwordx2 s[60:61], s[0:1], 64
  s_load_dwordx2 s[68:69], s[0:1], 72
  s_mov_b32 s66, 8192
  s_mov_b32 s67, 0x20000
  s_getreg_b32 s98, hwreg(HW_REG_XCC_ID, 0, 4)
  s_and_b32 s16, s5, 7
  s_cmp_eq_u32 s16, 0
  s_cselect_b32 s97, 1, 0
  s_cmp_eq_u32 s4, 7
  s_cselect_b32 s12, 0, 2
  s_cselect_b32 s97, 0, s97
  s_cmp_eq_u32 s97, 1
  s_cselect_b64 s[86:87], -1, 0
  s_cselect_b64 s[88:89], -1, 0
  s_cselect_b64 s[90:91], -1, 0
  s_cselect_b64 s[92:93], -1, 0
  s_cmp_lt_u32 s5, 16
  s_cselect_b32 s12, 1, s12
  s_lshl_b32 s26, s6, 5
  s_lshl_b32 s27, s4, 2
  s_add_u32 s26, s26, s27
  s_add_u32 s26, s26, s9
  s_lshl_b32 s26, s26, 11
  s_add_u32 s26, s26, 65536
  s_lshl_b32 s27, s4, 9
  s_add_u32 s27, s27, 16384
  s_lshl_b32 s72, s76, 12
  s_lshl_b32 s16, s9, 10
  s_add_u32 s72, s72, s16
  s_add_u32 s72, s72, 589824
  s_add_u32 s73, s72, 114688
  s_add_u32 s74, s72, 229376
  s_add_u32 s75, s72, 344064
  s_mov_b64 s[32:33], -1
  s_mov_b64 s[34:35], -1
  s_cmp_lg_u32 s9, 0
  s_cselect_b32 s30, 0, -1
  s_mov_b32 s31, 0
  s_waitcnt lgkmcnt(0)
  s_add_u32 s48, s48, 528482304
  s_addc_u32 s49, s49, 0
  s_load_dword s77, s[48:49], 0
  s_add_u32 s21, s20, 16384
  buffer_load_dwordx4 v[80:83], v4, s[40:43], s21 offen offset:0 nt
  buffer_load_dwordx4 v[84:87], v4, s[40:43], s21 offen offset:128 nt
  buffer_load_dwordx4 v[88:91], v4, s[40:43], s21 offen offset:2048 nt
  buffer_load_dwordx4 v[92:95], v4, s[40:43], s21 offen offset:2176 nt
  s_waitcnt lgkmcnt(0)
  s_mul_i32 s11, s77, 0x9e3779b1
  s_add_u32 s11, s11, 0x7f4a7c15
  s_lshl_b32 s16, s5, 4
  s_add_u32 s16, s16, s27
  v_mov_b32 v20, s98
  v_mov_b32 v21, s11
  v_mov_b32 v22, s98
  v_mov_b32 v23, s11
  s_and_b32 exec_lo, s30, 1
  s_mov_b32 exec_hi, 0
  buffer_store_dwordx4 v[20:23], v7, s[48:51], s16 offen
  s_mov_b64 exec, -1
  v_not_b32 v9, s11
  v_not_b32 v13, s11
  v_not_b32 v57, s11
  v_not_b32 v241, s11
  v_not_b32 v245, s11
  v_not_b32 v249, s11
  v_not_b32 v253, s11
  s_add_u32 s21, s20, 32768
  buffer_load_dwordx4 v[96:99], v4, s[40:43], s21 offen offset:0 nt
  buffer_load_dwordx4 v[100:103], v4, s[40:43], s21 offen offset:128 nt
  buffer_load_dwordx4 v[104:107], v4, s[40:43], s21 offen offset:2048 nt
  buffer_load_dwordx4 v[108:111], v4, s[40:43], s21 offen offset:2176 nt
  s_barrier
  s_add_u32 s21, s20, 49152
  buffer_load_dwordx4 v[112:115], v4, s[40:43], s21 offen offset:0 nt
  buffer_load_dwordx4 v[116:119], v4, s[40:43], s21 offen offset:128 nt
  buffer_load_dwordx4 v[120:123], v4, s[40:43], s21 offen offset:2048 nt
  buffer_load_dwordx4 v[124:127], v4, s[40:43], s21 offen offset:2176 nt
  s_add_u32 s21, s20, 65536
  buffer_load_dwordx4 v[128:131], v4, s[40:43], s21 offen offset:0 nt
  buffer_load_dwordx4 v[132:135], v4, s[40:43], s21 offen offset:128 nt
  buffer_load_dwordx4 v[136:139], v4, s[40:43], s21 offen offset:2048 nt
  buffer_load_dwordx4 v[140:143], v4, s[40:43], s21 offen offset:2176 nt
  s_add_u32 s21, s20, 81920
  buffer_load_dwordx4 v[144:147], v4, s[40:43], s21 offen offset:0 nt
  buffer_load_dwordx4 v[148:151], v4, s[40:43], s21 offen offset:128 nt
  buffer_load_dwordx4 v[152:155], v4, s[40:43], s21 offen offset:2048 nt
  buffer_load_dwordx4 v[156:159], v4, s[40:43], s21 offen offset:2176 nt
  s_add_u32 s21, s20, 98304
  buffer_load_dwordx4 v[160:163], v4, s[40:43], s21 offen offset:0 nt
  buffer_load_dwordx4 v[164:167], v4, s[40:43], s21 offen offset:128 nt
  buffer_load_dwordx4 v[168:171], v4, s[40:43], s21 offen offset:2048 nt
  buffer_load_dwordx4 v[172:175], v4, s[40:43], s21 offen offset:2176 nt
  s_add_u32 s21, s20, 114688
  buffer_load_dwordx4 v[176:179], v4, s[40:43], s21 offen offset:0 nt
  buffer_load_dwordx4 v[180:183], v4, s[40:43], s21 offen offset:128 nt
  buffer_load_dwordx4 v[184:187], v4, s[40:43], s21 offen offset:2048 nt
  buffer_load_dwordx4 v[188:191], v4, s[40:43], s21 offen offset:2176 nt
  s_mov_b64 exec, s[32:33]
  buffer_load_dwordx4 v[8:11], v16, s[48:51], s26 offen sc1
  s_mov_b64 exec, s[34:35]
  buffer_load_dwordx4 v[12:15], v16, s[48:51], s26 offen offset:1024 sc1
  s_mov_b64 exec, s[30:31]
  buffer_load_dwordx4 v[56:59], v16, s[48:51], s27 offen sc1
  s_mov_b64 exec, s[86:87]
  buffer_load_dwordx4 v[240:243], v16, s[48:51], s72 offen sc1
  s_mov_b64 exec, s[88:89]
  buffer_load_dwordx4 v[244:247], v16, s[48:51], s73 offen sc1
  s_mov_b64 exec, s[90:91]
  buffer_load_dwordx4 v[248:251], v16, s[48:51], s74 offen sc1
  s_mov_b64 exec, s[92:93]
  buffer_load_dwordx4 v[252:255], v16, s[48:51], s75 offen sc1
  s_mov_b64 exec, -1
  s_lshl_b32 s16, s9, 8
  v_lshrrev_b32 v17, 3, v1
  v_lshl_add_u32 v17, v17, 5, s16
  v_and_b32 v18, 3, v1
  v_lshl_add_u32 v17, v18, 3, v17
  v_bfe_u32 v18, v1, 2, 1
  v_lshl_add_u32 v17, v18, 2, v17
  v_and_b32 v18, 3, v2
  v_lshlrev_b32 v18, 8, v18
  v_lshrrev_b32 v20, 3, v2
  v_lshl_add_u32 v18, v20, 6, v18
  v_lshl_add_u32 v18, v3, 4, v18
  v_mov_b32 v50, 0xff800000
  s_mov_b32 s28, 0x3db504f3
  s_mov_b32 s29, 0x3db504f3
  v_lshlrev_b32 v21, 2, v1
  v_and_b32 v22, 3, v1
  v_lshlrev_b32 v22, 2, v22
  s_lshl_b32 s16, s9, 12
  s_add_u32 s16, s16, 47104
  v_add_u32 v23, s16, v16
  s_lshl_b32 s16, s9, 2
  v_mov_b32 v24, s16
  v_mov_b32 v51, 0
  s_cmp_eq_u32 s97, 0
  s_nop 0
  s_cbranch_scc1 L_w0
  s_waitcnt vmcnt(4)
  s_branch L_w1
L_w0:
  s_waitcnt vmcnt(0)
L_w1:
  s_cmp_lg_u32 s9, 0
  s_cbranch_scc1 L_nopl
  s_mov_b32 exec_hi, 0
  v_xor_b32 v6, s11, v57
  v_bitop3_b32 v6, v6, v59, s11 bitop3:0xf6
  v_bitop3_b32 v6, v6, v56, s98 bitop3:0xf6
  v_cmp_ne_u32 vcc, 0, v6
  s_mov_b64 exec, 1
  s_cmp_eq_u64 vcc, 0
  s_cselect_b32 s99, 1, 2
  v_mov_b32 v20, s99
  ds_write_b32 v7, v20 offset:76
  s_mov_b64 exec, -1
L_nopl:
  s_branch L_qchk
L_qpoll:
  s_mov_b64 exec, s[32:33]
  buffer_load_dwordx4 v[8:11], v16, s[48:51], s26 offen sc1
  s_mov_b64 exec, s[34:35]
  buffer_load_dwordx4 v[12:15], v16, s[48:51], s26 offen offset:1024 sc1
  s_mov_b64 exec, -1
  s_sleep 12
L_qchk:
  s_mov_b64 exec, s[32:33]
  v_xor_b32 v6, s11, v9
  v_bitop3_b32 v6, v6, v11, s11 bitop3:0xf6
  v_cmp_ne_u32 s[32:33], 0, v6
  s_mov_b64 exec, s[34:35]
  v_xor_b32 v6, s11, v13
  v_bitop3_b32 v6, v6, v15, s11 bitop3:0xf6
  v_cmp_ne_u32 s[34:35], 0, v6
  s_bcnt1_i32_b64 s79, s[32:33]
  s_bcnt1_i32_b64 s83, s[34:35]
  s_add_u32 s79, s79, s83
  s_mov_b64 exec, -1
  s_cmp_eq_u32 s79, 0
  s_cbranch_scc1 L_qok
  s_sub_u32 s82, s82, 1
  s_cbranch_scc0 L_qpoll
  s_branch L_bail
L_qok:
  v_add_f32 v20, v8, v12
  v_add_f32 v25, v10, v14
  v_cvt_pk_bf16_f32 v20, v20, v25
  ds_write_b32 v17, v20 offset:256
  s_mov_b64 exec, 1
  ds_add_u32 v7, v19 offset:72
  s_mov_b64 exec, -1
L_spin_1:
  ds_read_b32 v6, v7 offset:72
  ds_read_b128 v[40:43], v18 offset:256
  ds_read_b128 v[44:47], v18 offset:384
  s_waitcnt lgkmcnt(0)
  v_readfirstlane_b32 s3, v6
  s_cmp_eq_u32 s3, 4
  s_cbranch_scc1 L_spun_2
  s_sub_u32 s82, s82, 1
  s_nop 1
  s_cbranch_scc1 L_bail
  s_branch L_spin_1
L_spun_2:
  v_mfma_f32_16x16x32_bf16 v[192:195], v[64:67], v[40:43], 0
  v_mfma_f32_16x16x32_bf16 v[196:199], v[72:75], v[40:43], 0
  v_mfma_f32_16x16x32_bf16 v[200:203], v[80:83], v[40:43], 0
  v_mfma_f32_16x16x32_bf16 v[204:207], v[88:91], v[40:43], 0
  v_mfma_f32_16x16x32_bf16 v[192:195], v[68:71], v[44:47], v[192:195]
  v_mfma_f32_16x16x32_bf16 v[196:199], v[76:79], v[44:47], v[196:199]
  v_mfma_f32_16x16x32_bf16 v[200:203], v[84:87], v[44:47], v[200:203]
  v_mfma_f32_16x16x32_bf16 v[204:207], v[92:95], v[44:47], v[204:207]
  v_mfma_f32_16x16x32_bf16 v[208:211], v[96:99], v[40:43], 0
  v_mfma_f32_16x16x32_bf16 v[212:215], v[104:107], v[40:43], 0
  v_mfma_f32_16x16x32_bf16 v[216:219], v[112:115], v[40:43], 0
  v_mfma_f32_16x16x32_bf16 v[220:223], v[120:123], v[40:43], 0
  v_mfma_f32_16x16x32_bf16 v[208:211], v[100:103], v[44:47], v[208:211]
  v_mfma_f32_16x16x32_bf16 v[212:215], v[108:111], v[44:47], v[212:215]
  v_mfma_f32_16x16x32_bf16 v[216:219], v[116:119], v[44:47], v[216:219]
  v_mfma_f32_16x16x32_bf16 v[220:223], v[124:127], v[44:47], v[220:223]
  v_permlane32_swap_b32 v192, v196
  v_permlane32_swap_b32 v193, v197
  v_permlane32_swap_b32 v194, v198
  v_permlane32_swap_b32 v195, v199
  v_permlane32_swap_b32 v200, v204
  v_permlane32_swap_b32 v201, v205
  v_permlane32_swap_b32 v202, v206
  v_permlane32_swap_b32 v203, v207
  v_add_f32_dpp v224, v196, v192 row_ror:8 row_mask:0xf bank_mask:0x3
  v_add_f32_dpp v225, v197, v193 row_ror:8 row_mask:0xf bank_mask:0x3
  v_add_f32_dpp v226, v198, v194 row_ror:8 row_mask:0xf bank_mask:0x3
  v_add_f32_dpp v227, v199, v195 row_ror:8 row_mask:0xf bank_mask:0x3
  v_add_f32_dpp v224, v200, v204 row_ror:8 row_mask:0xf bank_mask:0xc
  v_add_f32_dpp v225, v201, v205 row_ror:8 row_mask:0xf bank_mask:0xc
  v_add_f32_dpp v226, v202, v206 row_ror:8 row_mask:0xf bank_mask:0xc
  v_add_f32_dpp v227, v203, v207 row_ror:8 row_mask:0xf bank_mask:0xc
  v_cvt_pk_bf16_f32 v52, v224, v225
  v_cvt_pk_bf16_f32 v53, v226, v227
  v_lshlrev_b32 v224, 16, v52
  v_and_b32 v225, 0xffff0000, v52
  v_lshlrev_b32 v226, 16, v53
  v_and_b32 v227, 0xffff0000, v53
  v_pk_mul_f32 v[224:225], v[224:225], s[28:29]
  v_pk_mul_f32 v[226:227], v[226:227], s[28:29]
  v_cvt_pk_bf16_f32 v52, v224, v225
  v_cvt_pk_bf16_f32 v53, v226, v227
  v_lshlrev_b32 v224, 16, v52
  v_and_b32 v225, 0xffff0000, v52
  v_lshlrev_b32 v226, 16, v53
  v_and_b32 v227, 0xffff0000, v53
  v_max3_f32 v50, v50, v224, v225
  v_max3_f32 v50, v50, v226, v227
  v_mfma_f32_16x16x32_bf16 v[192:195], v[128:131], v[40:43], 0
  v_mfma_f32_16x16x32_bf16 v[196:199], v[136:139], v[40:43], 0
  v_mfma_f32_16x16x32_bf16 v[200:203], v[144:147], v[40:43], 0
  v_mfma_f32_16x16x32_bf16 v[204:207], v[152:155], v[40:43], 0
  v_mfma_f32_16x16x32_bf16 v[192:195], v[132:135], v[44:47], v[192:195]
  v_mfma_f32_16x16x32_bf16 v[196:199], v[140:143], v[44:47], v[196:199]
  v_mfma_f32_16x16x32_bf16 v[200:203], v[148:151], v[44:47], v[200:203]
  v_mfma_f32_16x16x32_bf16 v[204:207], v[156:159], v[44:47], v[204:207]
  v_permlane32_swap_b32 v208, v212
  v_permlane32_swap_b32 v209, v213
  v_permlane32_swap_b32 v210, v214
  v_permlane32_swap_b32 v211, v215
  v_permlane32_swap_b32 v216, v220
  v_permlane32_swap_b32 v217, v221
  v_permlane32_swap_b32 v218, v222
  v_permlane32_swap_b32 v219, v223
  v_add_f32_dpp v228, v212, v208 row_ror:8 row_mask:0xf bank_mask:0x3
  v_add_f32_dpp v229, v213, v209 row_ror:8 row_mask:0xf bank_mask:0x3
  v_add_f32_dpp v230, v214, v210 row_ror:8 row_mask:0xf bank_mask:0x3
  v_add_f32_dpp v231, v215, v211 row_ror:8 row_mask:0xf bank_mask:0x3
  v_add_f32_dpp v228, v216, v220 row_ror:8 row_mask:0xf bank_mask:0xc
  v_add_f32_dpp v229, v217, v221 row_ror:8 row_mask:0xf bank_mask:0xc
  v_add_f32_dpp v230, v218, v222 row_ror:8 row_mask:0xf bank_mask:0xc
  v_add_f32_dpp v231, v219, v223 row_ror:8 row_mask:0xf bank_mask:0xc
  v_cvt_pk_bf16_f32 v52, v228, v229
  v_cvt_pk_bf16_f32 v53, v230, v231
  v_lshlrev_b32 v228, 16, v52
  v_and_b32 v229, 0xffff0000, v52
  v_lshlrev_b32 v230, 16, v53
  v_and_b32 v231, 0xffff0000, v53
  v_pk_mul_f32 v[228:229], v[228:229], s[28:29]
  v_pk_mul_f32 v[230:231], v[230:231], s[28:29]
  v_cvt_pk_bf16_f32 v52, v228, v229
  v_cvt_pk_bf16_f32 v53, v230, v231
  v_lshlrev_b32 v228, 16, v52
  v_and_b32 v229, 0xffff0000, v52
  v_lshlrev_b32 v230, 16, v53
  v_and_b32 v231, 0xffff0000, v53
  v_max3_f32 v50, v50, v228, v229
  v_max3_f32 v50, v50, v230, v231
  v_mfma_f32_16x16x32_bf16 v[208:211], v[160:163], v[40:43], 0
  v_mfma_f32_16x16x32_bf16 v[212:215], v[168:171], v[40:43], 0
  v_mfma_f32_16x16x32_bf16 v[216:219], v[176:179], v[40:43], 0
  v_mfma_f32_16x16x32_bf16 v[220:223], v[184:187], v[40:43], 0
  v_mfma_f32_16x16x32_bf16 v[208:211], v[164:167], v[44:47], v[208:211]
  v_mfma_f32_16x16x32_bf16 v[212:215], v[172:175], v[44:47], v[212:215]
  v_mfma_f32_16x16x32_bf16 v[216:219], v[180:183], v[44:47], v[216:219]
  v_mfma_f32_16x16x32_bf16 v[220:223], v[188:191], v[44:47], v[220:223]
  v_permlane32_swap_b32 v192, v196
  v_permlane32_swap_b32 v193, v197
  v_permlane32_swap_b32 v194, v198
  v_permlane32_swap_b32 v195, v199
  v_permlane32_swap_b32 v200, v204
  v_permlane32_swap_b32 v201, v205
  v_permlane32_swap_b32 v202, v206
  v_permlane32_swap_b32 v203, v207
  v_add_f32_dpp v232, v196, v192 row_ror:8 row_mask:0xf bank_mask:0x3
  v_add_f32_dpp v233, v197, v193 row_ror:8 row_mask:0xf bank_mask:0x3
  v_add_f32_dpp v234, v198, v194 row_ror:8 row_mask:0xf bank_mask:0x3
  v_add_f32_dpp v235, v199, v195 row_ror:8 row_mask:0xf bank_mask:0x3
  v_add_f32_dpp v232, v200, v204 row_ror:8 row_mask:0xf bank_mask:0xc
  v_add_f32_dpp v233, v201, v205 row_ror:8 row_mask:0xf bank_mask:0xc
  v_add_f32_dpp v234, v202, v206 row_ror:8 row_mask:0xf bank_mask:0xc
  v_add_f32_dpp v235, v203, v207 row_ror:8 row_mask:0xf bank_mask:0xc
  v_cvt_pk_bf16_f32 v52, v232, v233
  v_cvt_pk_bf16_f32 v53, v234, v235
  v_lshlrev_b32 v232, 16, v52
  v_and_b32 v233, 0xffff0000, v52
  v_lshlrev_b32 v234, 16, v53
  v_and_b32 v235, 0xffff0000, v53
  v_pk_mul_f32 v[232:233], v[232:233], s[28:29]
  v_pk_mul_f32 v[234:235], v[234:235], s[28:29]
  v_cvt_pk_bf16_f32 v52, v232, v233
  v_cvt_pk_bf16_f32 v53, v234, v235
  v_lshlrev_b32 v232, 16, v52
  v_and_b32 v233, 0xffff0000, v52
  v_lshlrev_b32 v234, 16, v53
  v_and_b32 v235, 0xffff0000, v53
  v_max3_f32 v50, v50, v232, v233
  v_max3_f32 v50, v50, v234, v235
  v_permlane32_swap_b32 v208, v212
  v_permlane32_swap_b32 v209, v213
  v_permlane32_swap_b32 v210, v214
  v_permlane32_swap_b32 v211, v215
  v_permlane32_swap_b32 v216, v220
  v_permlane32_swap_b32 v217, v221
  v_permlane32_swap_b32 v218, v222
  v_permlane32_swap_b32 v219, v223
  v_add_f32_dpp v236, v212, v208 row_ror:8 row_mask:0xf bank_mask:0x3
  v_add_f32_dpp v237, v213, v209 row_ror:8 row_mask:0xf bank_mask:0x3
  v_add_f32_dpp v238, v214, v210 row_ror:8 row_mask:0xf bank_mask:0x3
  v_add_f32_dpp v239, v215, v211 row_ror:8 row_mask:0xf bank_mask:0x3
  v_add_f32_dpp v236, v216, v220 row_ror:8 row_mask:0xf bank_mask:0xc
  v_add_f32_dpp v237, v217, v221 row_ror:8 row_mask:0xf bank_mask:0xc
  v_add_f32_dpp v238, v218, v222 row_ror:8 row_mask:0xf bank_mask:0xc
  v_add_f32_dpp v239, v219, v223 row_ror:8 row_mask:0xf bank_mask:0xc
  v_cvt_pk_bf16_f32 v52, v236, v237
  v_cvt_pk_bf16_f32 v53, v238, v239
  v_lshlrev_b32 v236, 16, v52
  v_and_b32 v237, 0xffff0000, v52
  v_lshlrev_b32 v238, 16, v53
  v_and_b32 v239, 0xffff0000, v53
  v_pk_mul_f32 v[236:237], v[236:237], s[28:29]
  v_pk_mul_f32 v[238:239], v[238:239], s[28:29]
  v_cvt_pk_bf16_f32 v52, v236, v237
  v_cvt_pk_bf16_f32 v53, v238, v239
  v_lshlrev_b32 v236, 16, v52
  v_and_b32 v237, 0xffff0000, v52
  v_lshlrev_b32 v238, 16, v53
  v_and_b32 v239, 0xffff0000, v53
  v_max3_f32 v50, v50, v236, v237
  v_max3_f32 v50, v50, v238, v239
  s_nop 1
  v_max_f32_dpp v50, v50, v50 row_ror:8 row_mask:0xf bank_mask:0xf
  v_mov_b32 v52, v50
  s_nop 1
  v_permlane32_swap_b32 v50, v52
  v_max_f32 v50, v50, v52
  v_mov_b32 v52, v50
  s_nop 1
  v_permlane16_swap_b32 v50, v52
  v_max_f32 v50, v50, v52
  s_mov_b64 exec, 15
  ds_max_f32 v21, v50 offset:16
  s_mov_b64 exec, 1
  ds_add_u32 v7, v19 offset:4
  s_mov_b64 exec, -1
  s_mov_b32 s28, 0x3fb8aa3b
L_spin_3:
  ds_read_b32 v6, v7 offset:4
  ds_read_b32 v50, v22 offset:16
  ds_read_b32 v53, v7 offset:76
  s_waitcnt lgkmcnt(0)
  v_readfirstlane_b32 s3, v6
  s_cmp_eq_u32 s3, 4
  s_cbranch_scc1 L_spun_4
  s_sub_u32 s82, s82, 1
  s_nop 1
  s_cbranch_scc1 L_bail
  s_branch L_spin_3
L_spun_4:
  v_mul_f32 v52, s28, v50
  v_readfirstlane_b32 s99, v53
  v_fma_f32 v224, v224, s28, -v52
  v_fma_f32 v225, v225, s28, -v52
  v_fma_f32 v226, v226, s28, -v52
  v_fma_f32 v227, v227, s28, -v52
  v_fma_f32 v228, v228, s28, -v52
  v_fma_f32 v229, v229, s28, -v52
  v_fma_f32 v230, v230, s28, -v52
  v_fma_f32 v231, v231, s28, -v52
  v_fma_f32 v232, v232, s28, -v52
  v_fma_f32 v233, v233, s28, -v52
  v_fma_f32 v234, v234, s28, -v52
  v_fma_f32 v235, v235, s28, -v52
  v_fma_f32 v236, v236, s28, -v52
  v_fma_f32 v237, v237, s28, -v52
  v_fma_f32 v238, v238, s28, -v52
  v_fma_f32 v239, v239, s28, -v52
  v_exp_f32 v224, v224
  v_exp_f32 v225, v225
  v_exp_f32 v226, v226
  v_exp_f32 v227, v227
  s_nop 0
  v_pk_add_f32 v[54:55], v[224:225], v[226:227]
  v_cvt_pk_bf16_f32 v192, v224, v224
  v_cvt_pk_bf16_f32 v193, v225, v225
  v_cvt_pk_bf16_f32 v194, v226, v226
  v_cvt_pk_bf16_f32 v195, v227, v227
  v_add_f32 v51, v51, v54
  ds_write_b128 v23, v[192:195] offset:0
  v_add_f32 v51, v51, v55
  v_exp_f32 v228, v228
  v_exp_f32 v229, v229
  v_exp_f32 v230, v230
  v_exp_f32 v231, v231
  s_nop 0
  v_pk_add_f32 v[54:55], v[228:229], v[230:231]
  v_cvt_pk_bf16_f32 v192, v228, v228
  v_cvt_pk_bf16_f32 v193, v229, v229
  v_cvt_pk_bf16_f32 v194, v230, v230
  v_cvt_pk_bf16_f32 v195, v231, v231
  v_add_f32 v51, v51, v54
  ds_write_b128 v23, v[192:195] offset:1024
  v_add_f32 v51, v51, v55
  v_exp_f32 v232, v232
  v_exp_f32 v233, v233
  v_exp_f32 v234, v234
  v_exp_f32 v235, v235
  s_nop 0
  v_pk_add_f32 v[54:55], v[232:233], v[234:235]
  v_cvt_pk_bf16_f32 v192, v232, v232
  v_cvt_pk_bf16_f32 v193, v233, v233
  v_cvt_pk_bf16_f32 v194, v234, v234
  v_cvt_pk_bf16_f32 v195, v235, v235
  v_add_f32 v51, v51, v54
  ds_write_b128 v23, v[192:195] offset:2048
  v_add_f32 v51, v51, v55
  v_exp_f32 v236, v236
  v_exp_f32 v237, v237
  v_exp_f32 v238, v238
  v_exp_f32 v239, v239
  s_nop 0
  v_pk_add_f32 v[54:55], v[236:237], v[238:239]
  v_cvt_pk_bf16_f32 v192, v236, v236
  v_cvt_pk_bf16_f32 v193, v237, v237
  v_cvt_pk_bf16_f32 v194, v238, v238
  v_cvt_pk_bf16_f32 v195, v239, v239
  v_add_f32 v51, v51, v54
  ds_write_b128 v23, v[192:195] offset:3072
  v_add_f32 v51, v51, v55
  s_mov_b64 exec, 1
  ds_write_b32 v24, v19 offset:48
  s_mov_b64 exec, -1
  v_add_f32_dpp v51, v51, v51 row_ror:8 row_mask:0xf bank_mask:0xf
  v_mov_b32 v53, v51
  s_nop 1
  v_permlane32_swap_b32 v51, v53
  v_add_f32 v51, v51, v53
  v_mov_b32 v53, v51
  s_nop 1
  v_permlane16_swap_b32 v51, v53
  v_add_f32 v51, v51, v53
  s_mov_b64 exec, 15
  ds_add_f32 v21, v51 offset:32
  s_mov_b64 exec, 1
  ds_add_u32 v7, v19 offset:8
  s_mov_b64 exec, -1
  s_cmp_lg_u32 s9, 0
  s_cbranch_scc1 L_noml
  s_cmp_eq_u32 s99, 1
  s_cbranch_scc1 L_norw
  s_cmp_eq_u32 s12, 0
  s_cbranch_scc1 L_norw
L_spin_5:
  ds_read_b32 v6, v7 offset:84
  s_waitcnt lgkmcnt(0)
  v_readfirstlane_b32 s3, v6
  s_cmp_eq_u32 s3, 4
  s_cbranch_scc1 L_spun_6
  s_sub_u32 s82, s82, 1
  s_nop 1
  s_cbranch_scc1 L_bail
  s_sleep 4
  s_branch L_spin_5
L_spun_6:
L_norw:
L_spin_7:
  ds_read_b32 v6, v7 offset:8
  ds_read_b32 v26, v22 offset:32
  s_waitcnt lgkmcnt(0)
  v_readfirstlane_b32 s3, v6
  s_cmp_eq_u32 s3, 4
  s_cbranch_scc1 L_spun_8
  s_sub_u32 s82, s82, 1
  s_nop 1
  s_cbranch_scc1 L_bail
  s_branch L_spin_7
L_spun_8:
  v_mov_b32 v24, v50
  v_mov_b32 v25, s11
  v_mov_b32 v27, s11
  v_lshlrev_b32 v20, 9, v1
  s_lshl_b32 s16, s4, 7
  s_add_u32 s16, s16, s5
  s_lshl_b32 s16, s16, 4
  s_add_u32 s16, s16, 32768
  s_mov_b64 exec, 15
  buffer_store_dwordx4 v[24:27], v20, s[48:51], s16 offen
  s_cmp_eq_u32 s99, 1
  s_nop 0
  s_cbranch_scc1 L_mlloc
  buffer_store_dwordx4 v[24:27], v20, s[48:51], s16 offen sc1
L_mlloc:
  s_mov_b64 exec, -1
L_noml:
  s_cmp_eq_u32 s97, 0
  s_cbranch_scc1 L_noh
  s_branch L_guchk
L_gupoll:
  s_mov_b64 exec, s[86:87]
  buffer_load_dwordx4 v[240:243], v16, s[48:51], s72 offen sc1
  s_mov_b64 exec, s[88:89]
  buffer_load_dwordx4 v[244:247], v16, s[48:51], s73 offen sc1
  s_mov_b64 exec, s[90:91]
  buffer_load_dwordx4 v[248:251], v16, s[48:51], s74 offen sc1
  s_mov_b64 exec, s[92:93]
  buffer_load_dwordx4 v[252:255], v16, s[48:51], s75 offen sc1
  s_mov_b64 exec, -1
  s_sleep 12
L_guchk:
  s_mov_b64 exec, s[86:87]
  s_cbranch_execz L_gusk0
  v_xor_b32 v6, s11, v241
  v_bitop3_b32 v6, v6, v243, s11 bitop3:0xf6
  v_cmp_ne_u32 s[86:87], 0, v6
L_gusk0:
  s_mov_b64 exec, s[88:89]
  s_cbranch_execz L_gusk1
  v_xor_b32 v6, s11, v245
  v_bitop3_b32 v6, v6, v247, s11 bitop3:0xf6
  v_cmp_ne_u32 s[88:89], 0, v6
L_gusk1:
  s_mov_b64 exec, s[90:91]
  s_cbranch_execz L_gusk2
  v_xor_b32 v6, s11, v249
  v_bitop3_b32 v6, v6, v251, s11 bitop3:0xf6
  v_cmp_ne_u32 s[90:91], 0, v6
L_gusk2:
  s_mov_b64 exec, s[92:93]
  s_cbranch_execz L_gusk3
  v_xor_b32 v6, s11, v253
  v_bitop3_b32 v6, v6, v255, s11 bitop3:0xf6
  v_cmp_ne_u32 s[92:93], 0, v6
L_gusk3:
  s_bcnt1_i32_b64 s79, s[86:87]
  s_bcnt1_i32_b64 s83, s[88:89]
  s_add_u32 s79, s79, s83
  s_bcnt1_i32_b64 s83, s[90:91]
  s_add_u32 s79, s79, s83
  s_bcnt1_i32_b64 s83, s[92:93]
  s_add_u32 s79, s79, s83
  s_mov_b64 exec, -1
  s_cmp_eq_u32 s79, 0
  s_cbranch_scc1 L_guok
  s_sub_u32 s82, s82, 1
  s_cbranch_scc0 L_gupoll
  s_branch L_bail
L_guok:
  s_mov_b32 s16, 0xbfb8aa3b
  v_add_f32 v32, v240, v244
  v_add_f32 v33, v242, v246
  v_add_f32 v34, v248, v252
  v_add_f32 v35, v250, v254
  v_cvt_pk_bf16_f32 v36, v32, v33
  v_cvt_pk_bf16_f32 v37, v34, v35
  v_lshlrev_b32 v32, 16, v36
  v_and_b32 v33, 0xffff0000, v36
  v_mul_f32 v32, s16, v32
  v_mul_f32 v33, s16, v33
  v_exp_f32 v32, v32
  v_exp_f32 v33, v33
  v_lshlrev_b32 v34, 16, v37
  v_and_b32 v35, 0xffff0000, v37
  v_add_f32 v32, 1.0, v32
  v_add_f32 v33, 1.0, v33
  v_rcp_f32 v32, v32
  v_rcp_f32 v33, v33
  v_lshrrev_b32 v20, 5, v1
  v_cvt_pk_bf16_f32 v36, v32, v33
  s_lshl_b32 s17, s9, 1
  v_add_u32 v20, s17, v20
  v_mul_u32_u24 v20, 144, v20
  v_lshlrev_b32 v32, 16, v36
  v_and_b32 v33, 0xffff0000, v36
  v_mul_f32 v32, v32, v34
  v_mul_f32 v33, v33, v35
  v_cvt_pk_bf16_f32 v22, v32, v33
  v_bfe_u32 v23, v1, 4, 1
  v_lshl_add_u32 v20, v23, 6, v20
  v_and_b32 v23, 3, v1
  v_lshl_add_u32 v20, v23, 4, v20
  v_bfe_u32 v23, v1, 3, 1
  v_lshl_add_u32 v20, v23, 3, v20
  v_bfe_u32 v23, v1, 2, 1
  v_lshl_add_u32 v20, v23, 2, v20
  ds_write_b32 v20, v22 offset:11776
  v_mov_b32 v23, s11
  v_lshlrev_b32 v20, 3, v1
  s_lshl_b32 s16, s76, 11
  s_lshl_b32 s17, s9, 9
  s_add_u32 s16, s16, s17
  s_add_u32 s16, s16, 1048576
  buffer_store_dwordx2 v[22:23], v20, s[48:51], s16 offen
  s_cmp_eq_u32 s99, 1
  s_cbranch_scc1 L_noh
  buffer_store_dwordx2 v[22:23], v20, s[48:51], s16 offen sc1
L_noh:
  s_add_u32 s78, s5, 4
  s_and_b32 s78, s78, 7
  s_cmp_lt_u32 s9, 2
  s_cbranch_scc1 L_nodma
  s_setprio 0
  s_mov_b32 s58, 4194304
  s_mov_b32 s59, 0x20000
  s_mov_b32 s62, 1835008
  s_mov_b32 s63, 0x20000
  v_lshrrev_b32 v36, 3, v1
  v_lshlrev_b32 v36, 10, v36
  v_and_b32 v37, 7, v1
  v_lshl_add_u32 v38, v37, 4, v36
  s_and_b32 s19, s9, 1
  s_lshl_b32 s16, s76, 17
  s_lshl_b32 s17, s19, 16
  s_add_u32 s16, s16, s17
  s_and_b32 s17, s5, 7
  s_lshl_b32 s17, s17, 7
  s_add_u32 s16, s16, s17
  s_lshl_b32 s17, s19, 13
  s_add_u32 s17, s17, 22528
  s_add_u32 m0, s17, 0
  v_xor_b32 v39, 0, v38
  buffer_load_dwordx4 v39, s[56:59], s16 offen nt lds
  s_add_u32 s16, s16, 8192
  s_add_u32 m0, s17, 1024
  v_xor_b32 v39, 32, v38
  buffer_load_dwordx4 v39, s[56:59], s16 offen nt lds
  s_add_u32 s16, s16, 8192
  s_add_u32 m0, s17, 2048
  v_xor_b32 v39, 64, v38
  buffer_load_dwordx4 v39, s[56:59], s16 offen nt lds
  s_add_u32 s16, s16, 8192
  s_add_u32 m0, s17, 3072
  v_xor_b32 v39, 96, v38
  buffer_load_dwordx4 v39, s[56:59], s16 offen nt lds
  s_add_u32 s16, s16, 8192
  s_add_u32 m0, s17, 4096
  v_xor_b32 v39, 0, v38
  buffer_load_dwordx4 v39, s[56:59], s16 offen nt lds
  s_add_u32 s16, s16, 8192
  s_add_u32 m0, s17, 5120
  v_xor_b32 v39, 32, v38
  buffer_load_dwordx4 v39, s[56:59], s16 offen nt lds
  s_add_u32 s16, s16, 8192
  s_add_u32 m0, s17, 6144
  v_xor_b32 v39, 64, v38
  buffer_load_dwordx4 v39, s[56:59], s16 offen nt lds
  s_add_u32 s16, s16, 8192
  s_add_u32 m0, s17, 7168
  v_xor_b32 v39, 96, v38
  buffer_load_dwordx4 v39, s[56:59], s16 offen nt lds
  s_add_u32 s16, s16, 8192
  v_lshlrev_b32 v38, 1, v3
  v_xor_b32 v38, v38, v37
  v_lshl_add_u32 v38, v38, 4, v36
  s_lshl_b32 s16, s76, 16
  s_lshl_b32 s17, s19, 15
  s_add_u32 s16, s16, s17
  s_lshl_b32 s17, s78, 7
  s_add_u32 s16, s16, s17
  s_lshl_b32 s17, s19, 12
  s_add_u32 s17, s17, 38912
  s_add_u32 m0, s17, 0
  s_nop 0
  buffer_load_dwordx4 v38, s[60:63], s16 offen nt lds
  s_add_u32 s16, s16, 8192
  s_add_u32 m0, s17, 1024
  s_nop 0
  buffer_load_dwordx4 v38, s[60:63], s16 offen nt lds
  s_add_u32 s16, s16, 8192
  s_add_u32 m0, s17, 2048
  s_nop 0
  buffer_load_dwordx4 v38, s[60:63], s16 offen nt lds
  s_add_u32 s16, s16, 8192
  s_add_u32 m0, s17, 3072
  s_nop 0
  buffer_load_dwordx4 v38, s[60:63], s16 offen nt lds
  s_add_u32 s16, s16, 8192
  s_setprio 1
  s_waitcnt vmcnt(4)
  s_mov_b64 exec, 1
  ds_add_u32 v7, v19 offset:88
  s_mov_b64 exec, -1
  s_branch L_kjoin
L_nodma:
  s_cmp_eq_u32 s9, 1
  s_cbranch_scc1 L_kw1
  s_cmp_eq_u32 s97, 1
  s_cbranch_scc1 L_kjoin
  s_cmp_eq_u32 s4, 7
  s_cbranch_scc1 L_kjoin
  s_lshl_b32 s72, s76, 11
  s_add_u32 s72, s72, 1048576
  v_mul_u32_u24 v23, 144, v3
  v_bfe_u32 v21, v1, 3, 1
  v_lshl_add_u32 v23, v21, 6, v23
  v_and_b32 v21, 1, v1
  v_lshl_add_u32 v23, v21, 5, v23
  v_bfe_u32 v21, v1, 2, 1
  v_lshl_add_u32 v23, v21, 3, v23
  v_bfe_u32 v21, v1, 1, 1
  v_lshl_add_u32 v23, v21, 2, v23
  v_add_u32 v23, 11776, v23
  v_not_b32 v241, s11
  s_mov_b64 s[32:33], -1
  v_not_b32 v245, s11
  s_mov_b64 s[34:35], -1
L_hpoll:
  s_mov_b64 exec, s[32:33]
  buffer_load_dwordx4 v[240:243], v16, s[48:51], s72 offen sc1
  s_mov_b64 exec, s[34:35]
  buffer_load_dwordx4 v[244:247], v16, s[48:51], s72 offen offset:1024 sc1
  s_mov_b64 exec, -1
  s_sleep 12
L_hchk:
  s_mov_b64 exec, s[32:33]
  v_xor_b32 v6, s11, v241
  v_bitop3_b32 v6, v6, v243, s11 bitop3:0xf6
  v_cmp_ne_u32 s[32:33], 0, v6
  s_mov_b64 exec, s[34:35]
  v_xor_b32 v6, s11, v245
  v_bitop3_b32 v6, v6, v247, s11 bitop3:0xf6
  v_cmp_ne_u32 s[34:35], 0, v6
  s_bcnt1_i32_b64 s79, s[32:33]
  s_bcnt1_i32_b64 s83, s[34:35]
  s_add_u32 s79, s79, s83
  s_mov_b64 exec, -1
  s_cmp_eq_u32 s79, 0
  s_cbranch_scc1 L_hok
  s_sub_u32 s82, s82, 1
  s_cbranch_scc0 L_hpoll
  s_branch L_bail
L_hok:
  ds_write2_b32 v23, v240, v242 offset0:0 offset1:4
  ds_write2_b32 v23, v244, v246 offset0:144 offset1:148
  s_branch L_kjoin
L_kw1:
  s_lshl_b32 s16, s76, 9
  s_add_u32 s16, s16, 32768
  v_lshlrev_b32 v21, 2, v1
  v_not_b32 v45, s11
  s_mov_b32 s32, 0xffffffff
  s_mov_b32 s33, 0x0
L_mlpoll:
  s_mov_b64 exec, s[32:33]
  buffer_load_dwordx4 v[44:47], v16, s[48:51], s16 offen sc1
  s_mov_b64 exec, -1
  s_sleep 8
L_mlchk:
  s_mov_b64 exec, s[32:33]
  v_xor_b32 v6, s11, v45
  v_bitop3_b32 v6, v6, v47, s11 bitop3:0xf6
  v_cmp_ne_u32 s[32:33], 0, v6
  s_bcnt1_i32_b64 s79, s[32:33]
  s_mov_b64 exec, -1
  s_cmp_eq_u32 s79, 0
  s_nop 1
  s_cbranch_scc1 L_mlok
  s_sub_u32 s82, s82, 1
  s_cbranch_scc0 L_mlpoll
  s_branch L_bail
L_mlok:
  s_mov_b32 s17, 0x3fb8aa3b
  v_max_f32_dpp v36, v44, v44 quad_perm:[1,0,3,2] row_mask:0xf bank_mask:0xf
  s_nop 1
  v_max_f32_dpp v36, v36, v36 quad_perm:[2,3,0,1] row_mask:0xf bank_mask:0xf
  v_sub_f32 v36, v44, v36
  v_mul_f32 v36, s17, v36
  v_exp_f32 v36, v36
  s_nop 0
  v_mul_f32 v37, v36, v46
  s_nop 1
  v_add_f32_dpp v37, v37, v37 quad_perm:[1,0,3,2] row_mask:0xf bank_mask:0xf
  s_nop 1
  v_add_f32_dpp v37, v37, v37 quad_perm:[2,3,0,1] row_mask:0xf bank_mask:0xf
  v_rcp_f32 v37, v37
  s_nop 0
  v_mul_f32 v36, v36, v37
  s_mov_b32 exec_hi, 0
  ds_write_b32 v21, v36 offset:128
  s_mov_b64 exec, 1
  ds_write_b32 v7, v19 offset:80
  s_mov_b64 exec, -1
L_kjoin:
  v_lshrrev_b32 v24, 2, v2
  v_lshl_add_u32 v24, v3, 2, v24
  v_lshlrev_b32 v25, 7, v24
  v_bfe_u32 v24, v24, 1, 2
  v_xor_b32 v24, s9, v24
  v_lshl_add_u32 v25, v24, 5, v25
  v_and_b32 v24, 3, v2
  v_lshl_add_u32 v25, v24, 3, v25
  v_and_b32 v27, 7, v2
  v_mul_u32_u24 v26, 144, v27
  v_lshl_add_u32 v26, v3, 4, v26
  s_mov_b32 s16, 131072
  v_mul_lo_u32 v27, v27, s16
  v_lshl_add_u32 v27, v3, 4, v27
  s_lshl_b32 s27, s78, 2
  s_add_u32 s27, s27, s9
  s_mul_i32 s27, s27, 32
  s_add_u32 s27, s27, s76
  s_lshl_b32 s27, s27, 7
  s_add_u32 s27, s27, 2097216
  s_and_b32 s94, s11, 0xfff
  v_mov_b32 v60, 0xfffff000
  s_mov_b32 s70, 8192
  s_mov_b32 s71, 0x20000
  s_lshl_b32 s17, s7, 3
  s_add_u32 s17, s17, s4
  s_lshl_b32 s16, s6, 5
  s_add_u32 s16, s16, s17
  s_lshl_b32 s18, s16, 5
  v_and_b32 v20, 3, v1
  v_lshlrev_b32 v20, 3, v20
  v_bfe_u32 v21, v1, 3, 1
  v_lshl_add_u32 v20, v21, 2, v20
  v_bfe_u32 v21, v1, 4, 1
  v_lshl_add_u32 v20, v21, 1, v20
  buffer_load_ushort v22, v20, s[64:67], s18 offen
  s_mul_i32 s16, s16, 4096
  s_add_u32 s16, s16, 2097152
  s_waitcnt vmcnt(0) lgkmcnt(0)
  s_mov_b64 exec, 1
  ds_add_u32 v7, v19 offset:64
  s_mov_b64 exec, -1
  s_cmp_eq_u32 s4, 7
  s_cbranch_scc1 L_nod
L_spin_9:
  ds_read_b32 v6, v7 offset:64
  s_waitcnt lgkmcnt(0)
  v_readfirstlane_b32 s3, v6
  s_cmp_eq_u32 s3, 4
  s_cbranch_scc1 L_spun_10
  s_sub_u32 s82, s82, 1
  s_nop 1
  s_cbranch_scc1 L_bail
  s_branch L_spin_9
L_spun_10:
  ds_read_b64_tr_b16 v[64:65], v25 offset:38912
  ds_read_b64_tr_b16 v[66:67], v25 offset:40960
  ds_read_b128 v[72:75], v26 offset:11776
  ds_read_b64_tr_b16 v[68:69], v25 offset:43008
  ds_read_b64_tr_b16 v[70:71], v25 offset:45056
  ds_read_b128 v[76:79], v26 offset:11840
  s_waitcnt lgkmcnt(3)
  v_mfma_f32_16x16x32_bf16 v[32:35], v[64:67], v[72:75], 0
  s_waitcnt lgkmcnt(0)
  v_mfma_f32_16x16x32_bf16 v[32:35], v[68:71], v[76:79], v[32:35]
  s_nop 7
  v_and_or_b32 v40, v32, v60, s94
  v_and_or_b32 v41, v33, v60, s94
  v_and_or_b32 v42, v34, v60, s94
  v_and_or_b32 v43, v35, v60, s94
L_spin_11:
  ds_read_b32 v6, v7 offset:68
  s_waitcnt lgkmcnt(0)
  v_readfirstlane_b32 s3, v6
  s_cmp_eq_u32 s3, 4
  s_cbranch_scc1 L_spun_12
  s_sub_u32 s82, s82, 1
  s_nop 1
  s_cbranch_scc1 L_bail
  s_sleep 1
  s_branch L_spin_11
L_spun_12:
  s_not_b64 exec, s[80:81]
  buffer_store_dwordx4 v[40:43], v27, s[48:51], s27 offen sc1
  s_mov_b64 exec, -1
L_nod:
  s_cmp_lg_u32 s9, 0
  s_cbranch_scc1 L_done
  v_not_b32 v64, s94
  s_mov_b64 s[20:21], -1
  v_not_b32 v68, s94
  s_mov_b64 s[22:23], -1
  v_not_b32 v72, s94
  s_mov_b64 s[24:25], -1
  v_not_b32 v76, s94
  s_mov_b64 s[26:27], -1
  s_mov_b32 s27, 0x0f0f0f0f
  s_mov_b32 s95, 0x800
  v_mov_b32 v92, 0
  v_mov_b32 v93, 0
  v_mov_b32 v94, 0
  v_mov_b32 v95, 0
  s_mov_b32 s79, 256
  v_mov_b32 v45, 0xfff
  v_lshlrev_b32 v48, 16, v22
  s_mov_b32 s17, 0xbfb8aa3b
L_spin_13:
  ds_read_b32 v6, v7 offset:68
  s_waitcnt lgkmcnt(0)
  v_readfirstlane_b32 s3, v6
  s_cmp_eq_u32 s3, 4
  s_cbranch_scc1 L_spun_14
  s_sub_u32 s82, s82, 1
  s_nop 1
  s_cbranch_scc1 L_bail
  s_sleep 1
  s_branch L_spin_13
L_spun_14:
  s_sleep 10
L_fpoll:
  s_mov_b64 exec, s[20:21]
  buffer_load_dwordx4 v[64:67], v16, s[48:51], s16 offen offset:0 sc1
  s_mov_b64 exec, s[22:23]
  buffer_load_dwordx4 v[68:71], v16, s[48:51], s16 offen offset:1024 sc1
  s_mov_b64 exec, s[24:25]
  buffer_load_dwordx4 v[72:75], v16, s[48:51], s16 offen offset:2048 sc1
  s_mov_b64 exec, s[26:27]
  buffer_load_dwordx4 v[76:79], v16, s[48:51], s16 offen offset:3072 sc1
  s_mov_b64 exec, -1
  s_cmp_lt_u32 s79, 65
  s_cbranch_scc1 L_fshort
  s_sleep 2
L_fshort:
  s_mov_b64 exec, s[20:21]
  s_cbranch_execz L_fsk0
  v_xor_b32 v6, s94, v64
  v_bitop3_b32 v6, v6, v65, s94 bitop3:0xf6
  v_bitop3_b32 v6, v6, v66, s94 bitop3:0xf6
  v_bitop3_b32 v6, v6, v67, s94 bitop3:0xf6
  v_and_b32 v6, v6, v45
  v_cmp_ne_u32 s[20:21], 0, v6
  v_and_or_b32 v80, v64, v60, s95
  v_and_or_b32 v81, v65, v60, s95
  v_and_or_b32 v82, v66, v60, s95
  v_and_or_b32 v83, v67, v60, s95
L_fsk0:
  s_mov_b64 exec, s[22:23]
  s_cbranch_execz L_fsk1
  v_xor_b32 v6, s94, v68
  v_bitop3_b32 v6, v6, v69, s94 bitop3:0xf6
  v_bitop3_b32 v6, v6, v70, s94 bitop3:0xf6
  v_bitop3_b32 v6, v6, v71, s94 bitop3:0xf6
  v_and_b32 v6, v6, v45
  v_cmp_ne_u32 s[22:23], 0, v6
  v_and_or_b32 v84, v68, v60, s95
  v_and_or_b32 v85, v69, v60, s95
  v_and_or_b32 v86, v70, v60, s95
  v_and_or_b32 v87, v71, v60, s95
L_fsk1:
  s_mov_b64 exec, s[24:25]
  s_cbranch_execz L_fsk2
  v_xor_b32 v6, s94, v72
  v_bitop3_b32 v6, v6, v73, s94 bitop3:0xf6
  v_bitop3_b32 v6, v6, v74, s94 bitop3:0xf6
  v_bitop3_b32 v6, v6, v75, s94 bitop3:0xf6
  v_and_b32 v6, v6, v45
  v_cmp_ne_u32 s[24:25], 0, v6
  v_and_or_b32 v88, v72, v60, s95
  v_and_or_b32 v89, v73, v60, s95
  v_and_or_b32 v90, v74, v60, s95
  v_and_or_b32 v91, v75, v60, s95
L_fsk2:
  s_mov_b64 exec, s[26:27]
  s_cbranch_execz L_fsk3
  v_xor_b32 v6, s94, v76
  v_bitop3_b32 v6, v6, v77, s94 bitop3:0xf6
  v_bitop3_b32 v6, v6, v78, s94 bitop3:0xf6
  v_bitop3_b32 v6, v6, v79, s94 bitop3:0xf6
  v_and_b32 v6, v6, v45
  v_cmp_ne_u32 s[26:27], 0, v6
  v_and_or_b32 v92, v76, v60, s95
  v_and_or_b32 v93, v77, v60, s95
  v_and_or_b32 v94, v78, v60, s95
  v_and_or_b32 v95, v79, v60, s95
L_fsk3:
  s_bcnt1_i32_b64 s79, s[20:21]
  s_bcnt1_i32_b64 s83, s[22:23]
  s_add_u32 s79, s79, s83
  s_bcnt1_i32_b64 s83, s[24:25]
  s_add_u32 s79, s79, s83
  s_bcnt1_i32_b64 s83, s[26:27]
  s_add_u32 s79, s79, s83
  s_mov_b64 exec, -1
  s_cmp_eq_u32 s79, 0
  s_cbranch_scc1 L_fok
  s_sub_u32 s82, s82, 1
  s_cbranch_scc0 L_fpoll
  s_branch L_bail
L_fok:
  v_pk_add_f32 v[96:97], v[80:81], v[84:85]
  v_pk_add_f32 v[98:99], v[82:83], v[86:87]
  v_pk_add_f32 v[100:101], v[88:89], v[92:93]
  v_pk_add_f32 v[102:103], v[90:91], v[94:95]
  v_pk_add_f32 v[96:97], v[96:97], v[100:101]
  v_pk_add_f32 v[98:99], v[98:99], v[102:103]
  s_nop 0
  v_add_f32_dpp v100, v96, v96 row_ror:8 row_mask:0xf bank_mask:0x3
  v_add_f32_dpp v101, v97, v97 row_ror:8 row_mask:0xf bank_mask:0x3
  v_add_f32_dpp v100, v98, v98 row_ror:8 row_mask:0xf bank_mask:0xc
  v_add_f32_dpp v101, v99, v99 row_ror:8 row_mask:0xf bank_mask:0xc
  s_nop 1
  v_permlane16_swap_b32 v100, v101
  v_add_f32 v100, v100, v101
  v_mov_b32 v101, v100
  s_nop 1
  v_permlane32_swap_b32 v100, v101
  v_add_f32 v100, v100, v101
  v_cvt_pk_bf16_f32 v100, v100, v100
  v_and_b32 v100, 0xffff0000, v100
  v_mul_f32 v101, s17, v100
  v_exp_f32 v101, v101
  s_nop 0
  v_add_f32 v101, 1.0, v101
  v_rcp_f32 v101, v101
  s_nop 0
  v_mul_f32 v101, v100, v101
  v_cvt_pk_bf16_f32 v101, v101, v101
  v_and_b32 v101, 0xffff0000, v101
  s_nop 1
  v_mul_f32_dpp v100, v101, v100 row_shl:4 row_mask:0xf bank_mask:0xf
  v_cvt_pk_bf16_f32 v100, v100, v100
  v_and_b32 v100, 0xffff0000, v100
  v_add_f32 v100, v100, v48
  v_cvt_pk_bf16_f32 v100, v100, v100
  s_mov_b32 exec_lo, 0x0f0f0f0f
  s_mov_b32 exec_hi, 0
  buffer_store_short v100, v20, s[68:71], s18 offen
  s_cmp_lg_u32 s2, 0
  s_cbranch_scc1 L_done
  s_mov_b64 exec, 1
  v_mov_b32 v33, s11
  buffer_store_dword v33, v7, s[48:51], 0 offen sc1
  s_nop 0
  s_branch L_done
L_a2:
  s_load_dwordx2 s[48:49], s[0:1], 88
  s_mov_b32 s50, 8388608
  s_mov_b32 s51, 0x20000
  s_mov_b32 s82, 2000000
  s_lshl_b32 s76, s4, 2
  s_lshr_b32 s16, s5, 3
  s_add_u32 s76, s76, s16
  v_and_b32 v2, 15, v1
  v_mov_b32 v7, 0
  v_lshlrev_b32 v16, 4, v1
  v_mov_b32 v19, 1
  s_mov_b32 s80, 0xff00ff00
  s_mov_b32 s81, 0xff00ff00
  s_load_dwordx2 s[44:45], s[0:1], 16
  s_lshr_b32 s6, s5, 2
  s_and_b32 s7, s5, 3
  s_lshl_b32 s20, s7, 5
  s_add_u32 s20, s20, s9
  s_lshl_b32 s20, s20, 12
  s_lshl_b32 s16, s6, 3
  s_add_u32 s16, s16, s4
  s_lshl_b32 s16, s16, 21
  s_add_u32 s20, s20, s16
  s_add_u32 s20, s20, 1572864
  s_mov_b32 s46, 0x8000000
  s_mov_b32 s47, 0x20000
  v_lshlrev_b32 v5, 10, v3
  v_lshl_add_u32 v5, v2, 4, v5
  v_mov_b32 v60, 0
  s_mov_b32 s96, 8388608
  s_cmp_lg_u32 s8, 0
  s_cbranch_scc1 L_noinit
  v_mov_b32 v8, 0
  v_mov_b32 v9, 0
  v_mov_b32 v10, 0
  v_mov_b32 v11, 0
  v_mov_b32 v12, 0xff800000
  v_mov_b32 v13, 0xff800000
  v_mov_b32 v14, 0xff800000
  v_mov_b32 v15, 0xff800000
  ds_write_b128 v7, v[8:11] offset:0
  ds_write_b128 v7, v[12:15] offset:16
  ds_write_b128 v7, v[8:11] offset:32
  ds_write_b128 v7, v[8:11] offset:48
  ds_write_b128 v7, v[8:11] offset:64
  ds_write_b128 v7, v[8:11] offset:80
L_noinit:
  s_waitcnt lgkmcnt(0)
  s_add_u32 s48, s48, 528482304
  s_addc_u32 s49, s49, 0
  s_load_dword s77, s[48:49], 0
  s_cmp_eq_u32 s12, 0
  s_cbranch_scc1 L_vbar
  v_lshrrev_b32 v17, 5, v1
  s_lshl_b32 s16, s9, 1
  v_add_u32 v17, s16, v17
  v_mul_u32_u24 v17, 1040, v17
  v_bfe_u32 v11, v1, 1, 4
  v_lshl_add_u32 v17, v11, 6, v17
  v_and_b32 v11, 1, v1
  v_lshl_add_u32 v17, v11, 3, v17
  v_lshrrev_b32 v11, 2, v2
  v_lshl_add_u32 v11, v3, 2, v11
  v_lshlrev_b32 v18, 7, v11
  v_bfe_u32 v11, v11, 1, 2
  v_xor_b32 v11, s9, v11
  v_lshl_add_u32 v18, v11, 5, v18
  v_and_b32 v11, 3, v2
  v_lshl_add_u32 v18, v11, 3, v18
  v_add_u32 v18, 63488, v18
  v_and_b32 v14, 7, v2
  v_mul_u32_u24 v20, 1040, v14
  v_lshl_add_u32 v20, v3, 4, v20
  s_lshl_b32 s16, s15, 9
  v_add_u32 v20, s16, v20
  v_lshrrev_b32 v15, 3, v2
  s_andn2_b32 s16, s13, 1
  s_add_u32 s16, s16, s15
  s_lshl_b32 s16, s16, 1
  s_and_b32 s17, s13, 1
  s_add_u32 s16, s16, s17
  s_lshl_b32 s16, s16, 9
  s_add_u32 s16, s16, 65536
  s_sub_u32 s17, s12, 2
  s_lshl_b32 s17, s17, 1
  s_add_u32 s17, s17, s15
  s_mul_i32 s17, s17, 28
  s_add_u32 s17, s17, s13
  s_lshl_b32 s17, s17, 12
  s_add_u32 s17, s17, 589824
  s_cmp_eq_u32 s12, 1
  s_cselect_b32 s96, s16, s17
  s_cselect_b32 s17, 16, 9
  s_lshl_b32 s16, s9, 7
  s_add_u32 s96, s96, s16
  v_lshlrev_b32 v60, s17, v14
  v_lshl_add_u32 v60, v15, 6, v60
  v_lshl_add_u32 v60, v3, 4, v60
  s_waitcnt vmcnt(8)
  v_lshlrev_b32 v80, 16, v64
  v_and_b32 v81, 0xffff0000, v64
  v_lshlrev_b32 v82, 16, v65
  v_and_b32 v83, 0xffff0000, v65
  v_lshlrev_b32 v84, 16, v66
  v_and_b32 v85, 0xffff0000, v66
  v_lshlrev_b32 v86, 16, v67
  v_and_b32 v87, 0xffff0000, v67
  v_lshlrev_b32 v88, 16, v68
  v_and_b32 v89, 0xffff0000, v68
  v_lshlrev_b32 v90, 16, v69
  v_and_b32 v91, 0xffff0000, v69
  v_lshlrev_b32 v92, 16, v70
  v_and_b32 v93, 0xffff0000, v70
  v_lshlrev_b32 v94, 16, v71
  v_and_b32 v95, 0xffff0000, v71
  v_pk_add_f32 v[96:97], v[80:81], v[82:83]
  v_pk_add_f32 v[98:99], v[84:85], v[86:87]
  v_pk_add_f32 v[100:101], v[88:89], v[90:91]
  v_pk_add_f32 v[102:103], v[92:93], v[94:95]
  v_pk_add_f32 v[96:97], v[96:97], v[98:99]
  v_pk_add_f32 v[100:101], v[100:101], v[102:103]
  v_pk_add_f32 v[96:97], v[96:97], v[100:101]
  v_add_f32 v10, v96, v97
  s_nop 1
  v_add_f32_dpp v10, v10, v10 quad_perm:[1,0,3,2] row_mask:0xf bank_mask:0xf
  s_nop 1
  v_add_f32_dpp v10, v10, v10 quad_perm:[2,3,0,1] row_mask:0xf bank_mask:0xf
  s_nop 1
  v_add_f32_dpp v10, v10, v10 row_half_mirror row_mask:0xf bank_mask:0xf
  s_nop 1
  v_add_f32_dpp v10, v10, v10 row_mirror row_mask:0xf bank_mask:0xf
  v_mov_b32 v11, v10
  s_nop 1
  v_permlane16_swap_b32 v10, v11
  v_add_f32 v10, v10, v11
  v_mul_f32 v10, 0x3b000000, v10
  v_mov_b32 v12, 0
  v_mov_b32 v13, 0
  v_sub_f32 v96, v80, v10
  v_sub_f32 v97, v81, v10
  v_sub_f32 v98, v82, v10
  v_sub_f32 v99, v83, v10
  v_sub_f32 v100, v84, v10
  v_sub_f32 v101, v85, v10
  v_sub_f32 v102, v86, v10
  v_sub_f32 v103, v87, v10
  v_sub_f32 v104, v88, v10
  v_sub_f32 v105, v89, v10
  v_sub_f32 v106, v90, v10
  v_sub_f32 v107, v91, v10
  v_sub_f32 v108, v92, v10
  v_sub_f32 v109, v93, v10
  v_sub_f32 v110, v94, v10
  v_sub_f32 v111, v95, v10
  v_fmac_f32 v12, v96, v96
  v_fmac_f32 v13, v97, v97
  v_fmac_f32 v12, v98, v98
  v_fmac_f32 v13, v99, v99
  v_fmac_f32 v12, v100, v100
  v_fmac_f32 v13, v101, v101
  v_fmac_f32 v12, v102, v102
  v_fmac_f32 v13, v103, v103
  v_fmac_f32 v12, v104, v104
  v_fmac_f32 v13, v105, v105
  v_fmac_f32 v12, v106, v106
  v_fmac_f32 v13, v107, v107
  v_fmac_f32 v12, v108, v108
  v_fmac_f32 v13, v109, v109
  v_fmac_f32 v12, v110, v110
  v_fmac_f32 v13, v111, v111
  v_add_f32 v12, v12, v13
  s_nop 1
  v_add_f32_dpp v12, v12, v12 quad_perm:[1,0,3,2] row_mask:0xf bank_mask:0xf
  s_nop 1
  v_add_f32_dpp v12, v12, v12 quad_perm:[2,3,0,1] row_mask:0xf bank_mask:0xf
  s_nop 1
  v_add_f32_dpp v12, v12, v12 row_half_mirror row_mask:0xf bank_mask:0xf
  s_nop 1
  v_add_f32_dpp v12, v12, v12 row_mirror row_mask:0xf bank_mask:0xf
  v_mov_b32 v11, v12
  s_nop 1
  v_permlane16_swap_b32 v12, v11
  v_add_f32 v12, v12, v11
  v_mul_f32 v12, 0x3b000000, v12
  v_cvt_pk_bf16_f32 v10, v10, v12
  v_and_b32 v12, 0xffff0000, v10
  v_lshlrev_b32 v10, 16, v10
  v_add_f32 v12, 0x3727c5ac, v12
  v_cvt_pk_bf16_f32 v12, v12, v12
  v_and_b32 v12, 0xffff0000, v12
  v_sqrt_f32 v12, v12
  s_nop 0
  v_cvt_pk_bf16_f32 v12, v12, v12
  v_and_b32 v12, 0xffff0000, v12
  v_rcp_f32 v13, v12
  v_sub_f32 v80, v80, v10
  v_sub_f32 v81, v81, v10
  v_sub_f32 v82, v82, v10
  v_sub_f32 v83, v83, v10
  v_sub_f32 v84, v84, v10
  v_sub_f32 v85, v85, v10
  v_sub_f32 v86, v86, v10
  v_sub_f32 v87, v87, v10
  v_sub_f32 v88, v88, v10
  v_sub_f32 v89, v89, v10
  v_sub_f32 v90, v90, v10
  v_sub_f32 v91, v91, v10
  v_sub_f32 v92, v92, v10
  v_sub_f32 v93, v93, v10
  v_sub_f32 v94, v94, v10
  v_sub_f32 v95, v95, v10
  v_cvt_pk_bf16_f32 v96, v80, v81
  v_cvt_pk_bf16_f32 v97, v82, v83
  v_cvt_pk_bf16_f32 v98, v84, v85
  v_cvt_pk_bf16_f32 v99, v86, v87
  v_cvt_pk_bf16_f32 v100, v88, v89
  v_cvt_pk_bf16_f32 v101, v90, v91
  v_cvt_pk_bf16_f32 v102, v92, v93
  v_cvt_pk_bf16_f32 v103, v94, v95
  v_lshlrev_b32 v80, 16, v96
  v_and_b32 v81, 0xffff0000, v96
  v_lshlrev_b32 v82, 16, v97
  v_and_b32 v83, 0xffff0000, v97
  v_lshlrev_b32 v84, 16, v98
  v_and_b32 v85, 0xffff0000, v98
  v_lshlrev_b32 v86, 16, v99
  v_and_b32 v87, 0xffff0000, v99
  v_lshlrev_b32 v88, 16, v100
  v_and_b32 v89, 0xffff0000, v100
  v_lshlrev_b32 v90, 16, v101
  v_and_b32 v91, 0xffff0000, v101
  v_lshlrev_b32 v92, 16, v102
  v_and_b32 v93, 0xffff0000, v102
  v_lshlrev_b32 v94, 16, v103
  v_and_b32 v95, 0xffff0000, v103
  v_mul_f32 v96, v80, v13
  v_mul_f32 v97, v81, v13
  v_mul_f32 v98, v82, v13
  v_mul_f32 v99, v83, v13
  v_mul_f32 v100, v84, v13
  v_mul_f32 v101, v85, v13
  v_mul_f32 v102, v86, v13
  v_mul_f32 v103, v87, v13
  v_mul_f32 v104, v88, v13
  v_mul_f32 v105, v89, v13
  v_mul_f32 v106, v90, v13
  v_mul_f32 v107, v91, v13
  v_mul_f32 v108, v92, v13
  v_mul_f32 v109, v93, v13
  v_mul_f32 v110, v94, v13
  v_mul_f32 v111, v95, v13
  v_fma_f32 v80, -v96, v12, v80
  v_fma_f32 v81, -v97, v12, v81
  v_fma_f32 v82, -v98, v12, v82
  v_fma_f32 v83, -v99, v12, v83
  v_fma_f32 v84, -v100, v12, v84
  v_fma_f32 v85, -v101, v12, v85
  v_fma_f32 v86, -v102, v12, v86
  v_fma_f32 v87, -v103, v12, v87
  v_fma_f32 v88, -v104, v12, v88
  v_fma_f32 v89, -v105, v12, v89
  v_fma_f32 v90, -v106, v12, v90
  v_fma_f32 v91, -v107, v12, v91
  v_fma_f32 v92, -v108, v12, v92
  v_fma_f32 v93, -v109, v12, v93
  v_fma_f32 v94, -v110, v12, v94
  v_fma_f32 v95, -v111, v12, v95
  v_fmac_f32 v96, v80, v13
  v_fmac_f32 v97, v81, v13
  v_fmac_f32 v98, v82, v13
  v_fmac_f32 v99, v83, v13
  v_fmac_f32 v100, v84, v13
  v_fmac_f32 v101, v85, v13
  v_fmac_f32 v102, v86, v13
  v_fmac_f32 v103, v87, v13
  v_fmac_f32 v104, v88, v13
  v_fmac_f32 v105, v89, v13
  v_fmac_f32 v106, v90, v13
  v_fmac_f32 v107, v91, v13
  v_fmac_f32 v108, v92, v13
  v_fmac_f32 v109, v93, v13
  v_fmac_f32 v110, v94, v13
  v_fmac_f32 v111, v95, v13
  v_cvt_pk_bf16_f32 v64, v96, v97
  v_cvt_pk_bf16_f32 v65, v98, v99
  v_cvt_pk_bf16_f32 v66, v100, v101
  v_cvt_pk_bf16_f32 v67, v102, v103
  v_cvt_pk_bf16_f32 v68, v104, v105
  v_cvt_pk_bf16_f32 v69, v106, v107
  v_cvt_pk_bf16_f32 v70, v108, v109
  v_cvt_pk_bf16_f32 v71, v110, v111
  ds_write_b64 v17, v[64:65] offset:1280
  ds_write_b64 v17, v[66:67] offset:1296
  ds_write_b64 v17, v[68:69] offset:1312
  ds_write_b64 v17, v[70:71] offset:1328
  s_barrier
  s_waitcnt vmcnt(0) lgkmcnt(0)
  s_mov_b64 exec, 1
  ds_add_u32 v7, v19 offset:0
  s_mov_b64 exec, -1
  s_mul_i32 s11, s77, 0x9e3779b1
  s_add_u32 s11, s11, 0x7f4a7c15
  v_mov_b32 v57, s11
  v_mov_b32 v59, s11
L_spin_15:
  ds_read_b32 v6, v7 offset:0
  s_waitcnt lgkmcnt(0)
  v_readfirstlane_b32 s3, v6
  s_cmp_eq_u32 s3, 4
  s_cbranch_scc1 L_spun_16
  s_sub_u32 s82, s82, 1
  s_nop 1
  s_cbranch_scc1 L_bail
  s_branch L_spin_15
L_spun_16:
  ds_read_b64_tr_b16 v[64:65], v18 offset:0
  ds_read_b64_tr_b16 v[66:67], v18 offset:2048
  ds_read_b128 v[68:71], v20 offset:1280
  ds_read_b64_tr_b16 v[72:73], v18 offset:4096
  ds_read_b64_tr_b16 v[74:75], v18 offset:6144
  ds_read_b128 v[76:79], v20 offset:1344
  ds_read_b64_tr_b16 v[80:81], v18 offset:8192
  ds_read_b64_tr_b16 v[82:83], v18 offset:10240
  ds_read_b128 v[84:87], v20 offset:1408
  ds_read_b64_tr_b16 v[88:89], v18 offset:12288
  ds_read_b64_tr_b16 v[90:91], v18 offset:14336
  ds_read_b128 v[92:95], v20 offset:1472
  ds_read_b64_tr_b16 v[96:97], v18 offset:16384
  ds_read_b64_tr_b16 v[98:99], v18 offset:18432
  ds_read_b128 v[100:103], v20 offset:1536
  s_waitcnt lgkmcnt(12)
  v_mfma_f32_16x16x32_bf16 v[32:35], v[64:67], v[68:71], 0
  ds_read_b64_tr_b16 v[104:105], v18 offset:20480
  ds_read_b64_tr_b16 v[106:107], v18 offset:22528
  ds_read_b128 v[108:111], v20 offset:1600
  s_waitcnt lgkmcnt(12)
  v_mfma_f32_16x16x32_bf16 v[36:39], v[72:75], v[76:79], 0
  ds_read_b64_tr_b16 v[112:113], v18 offset:24576
  ds_read_b64_tr_b16 v[114:115], v18 offset:26624
  ds_read_b128 v[116:119], v20 offset:1664
  s_waitcnt lgkmcnt(12)
  v_mfma_f32_16x16x32_bf16 v[32:35], v[80:83], v[84:87], v[32:35]
  ds_read_b64_tr_b16 v[120:121], v18 offset:28672
  ds_read_b64_tr_b16 v[122:123], v18 offset:30720
  ds_read_b128 v[124:127], v20 offset:1728
  s_waitcnt lgkmcnt(12)
  v_mfma_f32_16x16x32_bf16 v[36:39], v[88:91], v[92:95], v[36:39]
  s_waitcnt lgkmcnt(9)
  v_mfma_f32_16x16x32_bf16 v[32:35], v[96:99], v[100:103], v[32:35]
  s_waitcnt lgkmcnt(6)
  v_mfma_f32_16x16x32_bf16 v[36:39], v[104:107], v[108:111], v[36:39]
  s_waitcnt lgkmcnt(3)
  v_mfma_f32_16x16x32_bf16 v[32:35], v[112:115], v[116:119], v[32:35]
  s_waitcnt lgkmcnt(0)
  v_mfma_f32_16x16x32_bf16 v[36:39], v[120:123], v[124:127], v[36:39]
  s_nop 7
  v_pk_add_f32 v[32:33], v[32:33], v[36:37]
  v_pk_add_f32 v[34:35], v[34:35], v[38:39]
  v_cndmask_b32 v56, v32, v34, s[80:81]
  v_cndmask_b32 v58, v33, v35, s[80:81]
  buffer_store_dwordx4 v[56:59], v60, s[48:51], s96 offen
  s_nop 1
  s_branch L_vphase
L_vbar:
  s_barrier
L_vphase:
  v_lshrrev_b32 v20, 2, v2
  v_and_b32 v21, 1, v20
  v_lshlrev_b32 v21, 4, v21
  v_mov_b32 v22, 0xffff
  v_lshlrev_b32 v21, v21, v22
  v_cmp_gt_u32 vcc, 2, v20
  s_nop 1
  v_cndmask_b32 v48, 0, v21, vcc
  v_cndmask_b32 v49, v21, 0, vcc
  s_setprio 0
  s_add_u32 s21, s20, 0
  buffer_load_dwordx4 v[64:67], v5, s[44:47], s21 offen offset:0 nt
  buffer_load_dwordx4 v[68:71], v5, s[44:47], s21 offen offset:256 nt
  buffer_load_dwordx4 v[72:75], v5, s[44:47], s21 offen offset:512 nt
  buffer_load_dwordx4 v[76:79], v5, s[44:47], s21 offen offset:768 nt
  v_mov_b32 v32, 0
  v_mov_b32 v33, 0
  v_mov_b32 v34, 0
  v_mov_b32 v35, 0
  v_mov_b32 v36, 0
  v_mov_b32 v37, 0
  v_mov_b32 v38, 0
  v_mov_b32 v39, 0
  s_lshl_b32 s16, s9, 12
  s_add_u32 s16, s16, 47104
  v_and_b32 v20, 3, v2
  v_lshl_add_u32 v20, v3, 4, v20
  v_lshl_add_u32 v20, v20, 4, s16
  s_lshl_b32 s16, s9, 2
  v_mov_b32 v21, s16
  v_add_u32 v22, v1, v3
  v_lshlrev_b32 v22, 4, v22
  s_mul_i32 s16, s9, 2304
  s_add_u32 s16, s16, 12928
  v_add_u32 v22, s16, v22
  v_bfe_u32 v23, v1, 4, 1
  v_mul_u32_u24 v23, 1152, v23
  v_bfe_u32 v24, v1, 2, 2
  v_mul_u32_u24 v24, 272, v24
  v_add_u32 v23, v23, v24
  v_and_b32 v24, 3, v1
  v_lshl_add_u32 v23, v24, 6, v23
  s_lshl_b32 s16, s9, 4
  s_add_u32 s16, s16, 12928
  v_add_u32 v23, s16, v23
  s_lshl_b32 s30, s6, 5
  s_lshl_b32 s17, s4, 2
  s_add_u32 s30, s30, s17
  s_add_u32 s30, s30, s9
  s_lshl_b32 s30, s30, 2
  s_add_u32 s30, s30, s7
  s_lshl_b32 s30, s30, 9
  s_add_u32 s30, s30, 65536
  s_add_u32 s21, s20, 16384
  buffer_load_dwordx4 v[80:83], v5, s[44:47], s21 offen offset:0 nt
  buffer_load_dwordx4 v[84:87], v5, s[44:47], s21 offen offset:256 nt
  buffer_load_dwordx4 v[88:91], v5, s[44:47], s21 offen offset:512 nt
  buffer_load_dwordx4 v[92:95], v5, s[44:47], s21 offen offset:768 nt
  v_lshrrev_b32 v27, 5, v1
  s_lshl_b32 s18, s9, 5
  v_lshl_add_u32 v17, v27, 4, s18
  s_lshl_b32 s22, s9, 6
  s_add_u32 s22, s22, s76
  s_lshl_b32 s22, s22, 11
  s_add_u32 s22, s22, 65536
  v_and_b32 v29, 31, v1
  v_lshlrev_b32 v18, 16, v27
  v_lshl_add_u32 v18, v29, 4, v18
  s_lshl_b32 s18, s9, 1
  v_add_u32 v24, s18, v27
  v_mul_u32_u24 v24, 272, v24
  v_lshl_add_u32 v24, v29, 3, v24
  v_and_b32 v28, 7, v2
  v_mul_u32_u24 v25, 272, v28
  v_lshl_add_u32 v25, v3, 4, v25
  v_lshrrev_b32 v26, 1, v3
  v_lshlrev_b32 v26, 5, v26
  v_lshrrev_b32 v27, 2, v2
  v_lshl_add_u32 v26, v27, 3, v26
  v_and_b32 v29, 1, v3
  v_lshl_add_u32 v26, v29, 1, v26
  v_lshlrev_b32 v26, 7, v26
  v_xor_b32 v27, s9, v27
  v_lshl_add_u32 v26, v27, 5, v26
  v_and_b32 v29, 3, v2
  v_lshl_add_u32 v26, v29, 3, v26
  s_mov_b32 s17, 131072
  v_mul_lo_u32 v28, v28, s17
  v_lshl_add_u32 v28, v3, 4, v28
  s_and_b32 s17, s5, 7
  s_lshl_b32 s17, s17, 2
  s_add_u32 s17, s17, s9
  s_mul_i32 s17, s17, 32
  s_add_u32 s17, s17, s76
  s_lshl_b32 s17, s17, 7
  s_add_u32 s74, s17, 2097152
  s_waitcnt lgkmcnt(0)
  s_mul_i32 s11, s77, 0x9e3779b1
  s_add_u32 s11, s11, 0x7f4a7c15
  s_xor_b32 s10, s11, 0x80000000
  v_mov_b32 v9, s10
  v_mov_b32 v11, s10
  s_and_b32 s94, s11, 0xfff
  v_mov_b32 v30, 0xfffff000
  s_nop 0
  s_add_u32 s21, s20, 32768
  buffer_load_dwordx4 v[96:99], v5, s[44:47], s21 offen offset:0 nt
  buffer_load_dwordx4 v[100:103], v5, s[44:47], s21 offen offset:256 nt
  buffer_load_dwordx4 v[104:107], v5, s[44:47], s21 offen offset:512 nt
  buffer_load_dwordx4 v[108:111], v5, s[44:47], s21 offen offset:768 nt
  s_add_u32 s21, s20, 49152
  buffer_load_dwordx4 v[112:115], v5, s[44:47], s21 offen offset:0 nt
  buffer_load_dwordx4 v[116:119], v5, s[44:47], s21 offen offset:256 nt
  buffer_load_dwordx4 v[120:123], v5, s[44:47], s21 offen offset:512 nt
  buffer_load_dwordx4 v[124:127], v5, s[44:47], s21 offen offset:768 nt
  s_add_u32 s21, s20, 65536
  buffer_load_dwordx4 v[128:131], v5, s[44:47], s21 offen offset:0 nt
  buffer_load_dwordx4 v[132:135], v5, s[44:47], s21 offen offset:256 nt
  buffer_load_dwordx4 v[136:139], v5, s[44:47], s21 offen offset:512 nt
  buffer_load_dwordx4 v[140:143], v5, s[44:47], s21 offen offset:768 nt
  s_add_u32 s21, s20, 81920
  buffer_load_dwordx4 v[144:147], v5, s[44:47], s21 offen offset:0 nt
  buffer_load_dwordx4 v[148:151], v5, s[44:47], s21 offen offset:256 nt
  buffer_load_dwordx4 v[152:155], v5, s[44:47], s21 offen offset:512 nt
  buffer_load_dwordx4 v[156:159], v5, s[44:47], s21 offen offset:768 nt
  s_add_u32 s21, s20, 98304
  buffer_load_dwordx4 v[160:163], v5, s[44:47], s21 offen offset:0 nt
  buffer_load_dwordx4 v[164:167], v5, s[44:47], s21 offen offset:256 nt
  buffer_load_dwordx4 v[168:171], v5, s[44:47], s21 offen offset:512 nt
  buffer_load_dwordx4 v[172:175], v5, s[44:47], s21 offen offset:768 nt
  s_add_u32 s21, s20, 114688
  buffer_load_dwordx4 v[176:179], v5, s[44:47], s21 offen offset:0 nt
  buffer_load_dwordx4 v[180:183], v5, s[44:47], s21 offen offset:256 nt
  buffer_load_dwordx4 v[184:187], v5, s[44:47], s21 offen offset:512 nt
  buffer_load_dwordx4 v[188:191], v5, s[44:47], s21 offen offset:768 nt
  s_setprio 3
L_mode:
  ds_read_b32 v6, v7 offset:76
  s_waitcnt lgkmcnt(0)
  v_readfirstlane_b32 s99, v6
  s_cmp_eq_u32 s99, 1
  s_nop 3
  s_cbranch_scc1 L_modeok
  s_cmp_eq_u32 s99, 2
  s_cbranch_scc1 L_repub
  s_sub_u32 s82, s82, 1
  s_cbranch_scc1 L_bail
  s_sleep 1
  s_branch L_mode
L_repub:
  s_cmp_eq_u32 s12, 0
  s_cbranch_scc1 L_modeok
  buffer_store_dwordx4 v[56:59], v60, s[48:51], s96 offen sc1
  s_waitcnt vmcnt(0)
  s_mov_b64 exec, 1
  ds_add_u32 v7, v19 offset:84
  s_mov_b64 exec, -1
L_modeok:
L_spin_17:
  ds_read_b32 v6, v21 offset:48
  ds_read_b128 v[192:195], v20 offset:0
  ds_read_b128 v[196:199], v20 offset:128
  ds_read_b128 v[200:203], v20 offset:1024
  ds_read_b128 v[204:207], v20 offset:1152
  ds_read_b128 v[208:211], v20 offset:2048
  ds_read_b128 v[212:215], v20 offset:2176
  ds_read_b128 v[216:219], v20 offset:3072
  ds_read_b128 v[220:223], v20 offset:3200
  s_waitcnt lgkmcnt(0)
  v_readfirstlane_b32 s3, v6
  s_cmp_eq_u32 s3, 1
  s_cbranch_scc1 L_spun_18
  s_sub_u32 s82, s82, 1
  s_nop 1
  s_cbranch_scc1 L_bail
  s_sleep 1
  s_branch L_spin_17
L_spun_18:
  v_and_b32 v40, v192, v48
  v_and_b32 v41, v192, v49
  v_and_b32 v42, v193, v48
  v_and_b32 v43, v193, v49
  v_and_b32 v44, v194, v48
  v_and_b32 v45, v194, v49
  v_and_b32 v46, v195, v48
  v_and_b32 v47, v195, v49
  s_waitcnt vmcnt(28)
  v_swap_b32 v66, v68
  v_swap_b32 v67, v69
  s_nop 1
  v_mfma_f32_16x16x32_bf16 v[32:35], v[64:67], v[40:43], v[32:35]
  v_swap_b32 v74, v76
  v_swap_b32 v75, v77
  v_mfma_f32_16x16x32_bf16 v[36:39], v[68:71], v[40:43], v[36:39]
  s_nop 0
  v_mfma_f32_16x16x32_bf16 v[32:35], v[72:75], v[44:47], v[32:35]
  v_mfma_f32_16x16x32_bf16 v[36:39], v[76:79], v[44:47], v[36:39]
  v_and_b32 v40, v196, v48
  v_and_b32 v41, v196, v49
  v_and_b32 v42, v197, v48
  v_and_b32 v43, v197, v49
  v_and_b32 v44, v198, v48
  v_and_b32 v45, v198, v49
  v_and_b32 v46, v199, v48
  v_and_b32 v47, v199, v49
  s_waitcnt vmcnt(24)
  v_swap_b32 v82, v84
  v_swap_b32 v83, v85
  s_nop 1
  v_mfma_f32_16x16x32_bf16 v[32:35], v[80:83], v[40:43], v[32:35]
  v_swap_b32 v90, v92
  v_swap_b32 v91, v93
  v_mfma_f32_16x16x32_bf16 v[36:39], v[84:87], v[40:43], v[36:39]
  s_nop 0
  v_mfma_f32_16x16x32_bf16 v[32:35], v[88:91], v[44:47], v[32:35]
  v_mfma_f32_16x16x32_bf16 v[36:39], v[92:95], v[44:47], v[36:39]
  v_and_b32 v40, v200, v48
  v_and_b32 v41, v200, v49
  v_and_b32 v42, v201, v48
  v_and_b32 v43, v201, v49
  v_and_b32 v44, v202, v48
  v_and_b32 v45, v202, v49
  v_and_b32 v46, v203, v48
  v_and_b32 v47, v203, v49
  s_waitcnt vmcnt(20)
  v_swap_b32 v98, v100
  v_swap_b32 v99, v101
  s_nop 1
  v_mfma_f32_16x16x32_bf16 v[32:35], v[96:99], v[40:43], v[32:35]
  v_swap_b32 v106, v108
  v_swap_b32 v107, v109
  v_mfma_f32_16x16x32_bf16 v[36:39], v[100:103], v[40:43], v[36:39]
  s_nop 0
  v_mfma_f32_16x16x32_bf16 v[32:35], v[104:107], v[44:47], v[32:35]
  v_mfma_f32_16x16x32_bf16 v[36:39], v[108:111], v[44:47], v[36:39]
  v_and_b32 v40, v204, v48
  v_and_b32 v41, v204, v49
  v_and_b32 v42, v205, v48
  v_and_b32 v43, v205, v49
  v_and_b32 v44, v206, v48
  v_and_b32 v45, v206, v49
  v_and_b32 v46, v207, v48
  v_and_b32 v47, v207, v49
  s_waitcnt vmcnt(16)
  v_swap_b32 v114, v116
  v_swap_b32 v115, v117
  s_nop 1
  v_mfma_f32_16x16x32_bf16 v[32:35], v[112:115], v[40:43], v[32:35]
  v_swap_b32 v122, v124
  v_swap_b32 v123, v125
  v_mfma_f32_16x16x32_bf16 v[36:39], v[116:119], v[40:43], v[36:39]
  s_nop 0
  v_mfma_f32_16x16x32_bf16 v[32:35], v[120:123], v[44:47], v[32:35]
  v_mfma_f32_16x16x32_bf16 v[36:39], v[124:127], v[44:47], v[36:39]
  v_and_b32 v40, v208, v48
  v_and_b32 v41, v208, v49
  v_and_b32 v42, v209, v48
  v_and_b32 v43, v209, v49
  v_and_b32 v44, v210, v48
  v_and_b32 v45, v210, v49
  v_and_b32 v46, v211, v48
  v_and_b32 v47, v211, v49
  s_waitcnt vmcnt(12)
  v_swap_b32 v130, v132
  v_swap_b32 v131, v133
  s_nop 1
  v_mfma_f32_16x16x32_bf16 v[32:35], v[128:131], v[40:43], v[32:35]
  v_swap_b32 v138, v140
  v_swap_b32 v139, v141
  v_mfma_f32_16x16x32_bf16 v[36:39], v[132:135], v[40:43], v[36:39]
  s_nop 0
  v_mfma_f32_16x16x32_bf16 v[32:35], v[136:139], v[44:47], v[32:35]
  v_mfma_f32_16x16x32_bf16 v[36:39], v[140:143], v[44:47], v[36:39]
  v_and_b32 v40, v212, v48
  v_and_b32 v41, v212, v49
  v_and_b32 v42, v213, v48
  v_and_b32 v43, v213, v49
  v_and_b32 v44, v214, v48
  v_and_b32 v45, v214, v49
  v_and_b32 v46, v215, v48
  v_and_b32 v47, v215, v49
  s_waitcnt vmcnt(8)
  v_swap_b32 v146, v148
  v_swap_b32 v147, v149
  s_nop 1
  v_mfma_f32_16x16x32_bf16 v[32:35], v[144:147], v[40:43], v[32:35]
  v_swap_b32 v154, v156
  v_swap_b32 v155, v157
  v_mfma_f32_16x16x32_bf16 v[36:39], v[148:151], v[40:43], v[36:39]
  s_nop 0
  v_mfma_f32_16x16x32_bf16 v[32:35], v[152:155], v[44:47], v[32:35]
  v_mfma_f32_16x16x32_bf16 v[36:39], v[156:159], v[44:47], v[36:39]
  v_and_b32 v40, v216, v48
  v_and_b32 v41, v216, v49
  v_and_b32 v42, v217, v48
  v_and_b32 v43, v217, v49
  v_and_b32 v44, v218, v48
  v_and_b32 v45, v218, v49
  v_and_b32 v46, v219, v48
  v_and_b32 v47, v219, v49
  s_waitcnt vmcnt(4)
  v_swap_b32 v162, v164
  v_swap_b32 v163, v165
  s_nop 1
  v_mfma_f32_16x16x32_bf16 v[32:35], v[160:163], v[40:43], v[32:35]
  v_swap_b32 v170, v172
  v_swap_b32 v171, v173
  v_mfma_f32_16x16x32_bf16 v[36:39], v[164:167], v[40:43], v[36:39]
  s_nop 0
  v_mfma_f32_16x16x32_bf16 v[32:35], v[168:171], v[44:47], v[32:35]
  v_mfma_f32_16x16x32_bf16 v[36:39], v[172:175], v[44:47], v[36:39]
  v_and_b32 v40, v220, v48
  v_and_b32 v41, v220, v49
  v_and_b32 v42, v221, v48
  v_and_b32 v43, v221, v49
  v_and_b32 v44, v222, v48
  v_and_b32 v45, v222, v49
  v_and_b32 v46, v223, v48
  v_and_b32 v47, v223, v49
L_spin_19:
  ds_read_b32 v6, v7 offset:80
  ds_read_b128 v[232:235], v17 offset:128
  s_waitcnt lgkmcnt(0)
  v_readfirstlane_b32 s3, v6
  s_cmp_eq_u32 s3, 1
  s_cbranch_scc1 L_spun_20
  s_sub_u32 s82, s82, 1
  s_nop 1
  s_cbranch_scc1 L_bail
  s_sleep 1
  s_branch L_spin_19
L_spun_20:
  s_waitcnt vmcnt(0)
  v_swap_b32 v178, v180
  v_swap_b32 v179, v181
  s_nop 1
  v_mfma_f32_16x16x32_bf16 v[32:35], v[176:179], v[40:43], v[32:35]
  v_swap_b32 v186, v188
  v_swap_b32 v187, v189
  v_mfma_f32_16x16x32_bf16 v[36:39], v[180:183], v[40:43], v[36:39]
  s_nop 0
  v_mfma_f32_16x16x32_bf16 v[32:35], v[184:187], v[44:47], v[32:35]
  v_mfma_f32_16x16x32_bf16 v[36:39], v[188:191], v[44:47], v[36:39]
  s_nop 6
  ds_write_b128 v22, v[32:35]
  ds_write_b128 v22, v[36:39] offset:1152
  s_mov_b64 exec, 1
  ds_add_u32 v7, v19 offset:12
  s_mov_b64 exec, -1
  v_not_b32 v65, s10
  s_mov_b64 s[12:13], -1
  v_not_b32 v69, s10
  s_mov_b64 s[14:15], -1
  v_not_b32 v73, s10
  s_mov_b64 s[16:17], -1
  v_not_b32 v77, s10
  s_mov_b64 s[18:19], -1
L_spin_21:
  ds_read_b32 v6, v7 offset:12
  ds_read_b128 v[96:99], v23 offset:0
  ds_read_b128 v[100:103], v23 offset:2304
  ds_read_b128 v[104:107], v23 offset:4608
  ds_read_b128 v[108:111], v23 offset:6912
  s_waitcnt lgkmcnt(0)
  v_readfirstlane_b32 s3, v6
  s_cmp_eq_u32 s3, 4
  s_cbranch_scc1 L_spun_22
  s_sub_u32 s82, s82, 1
  s_nop 1
  s_cbranch_scc1 L_bail
  s_branch L_spin_21
L_spun_22:
  v_pk_add_f32 v[96:97], v[96:97], v[100:101]
  v_pk_add_f32 v[98:99], v[98:99], v[102:103]
  v_pk_add_f32 v[104:105], v[104:105], v[108:109]
  v_pk_add_f32 v[106:107], v[106:107], v[110:111]
  v_pk_add_f32 v[96:97], v[96:97], v[104:105]
  v_pk_add_f32 v[98:99], v[98:99], v[106:107]
  v_cvt_pk_bf16_f32 v8, v96, v97
  v_cvt_pk_bf16_f32 v10, v98, v99
  s_mov_b32 exec_hi, 0
  buffer_store_dwordx4 v[8:11], v16, s[48:51], s30 offen
  s_cmp_eq_u32 s99, 1
  s_nop 0
  s_cbranch_scc1 L_oploc
  buffer_store_dwordx4 v[8:11], v16, s[48:51], s30 offen sc1
L_oploc:
  s_mov_b64 exec, -1
  s_mov_b32 s79, 256
  s_mov_b64 exec, s[12:13]
  buffer_load_dwordx4 v[64:67], v18, s[48:51], s22 offen offset:0 sc1
  s_mov_b64 exec, s[14:15]
  buffer_load_dwordx4 v[68:71], v18, s[48:51], s22 offen offset:512 sc1
  s_mov_b64 exec, s[16:17]
  buffer_load_dwordx4 v[72:75], v18, s[48:51], s22 offen offset:1024 sc1
  s_mov_b64 exec, s[18:19]
  buffer_load_dwordx4 v[76:79], v18, s[48:51], s22 offen offset:1536 sc1
  s_mov_b64 exec, -1
L_spin_23:
  ds_read_b32 v6, v7 offset:88
  ds_read_b64_tr_b16 v[128:129], v26 offset:22528
  ds_read_b64_tr_b16 v[130:131], v26 offset:22656
  ds_read_b64_tr_b16 v[132:133], v26 offset:30720
  ds_read_b64_tr_b16 v[134:135], v26 offset:30848
  ds_read_b64_tr_b16 v[136:137], v26 offset:23040
  ds_read_b64_tr_b16 v[138:139], v26 offset:23168
  ds_read_b64_tr_b16 v[140:141], v26 offset:31232
  ds_read_b64_tr_b16 v[142:143], v26 offset:31360
  s_waitcnt lgkmcnt(0)
  v_readfirstlane_b32 s3, v6
  s_cmp_eq_u32 s3, 2
  s_cbranch_scc1 L_spun_24
  s_sub_u32 s82, s82, 1
  s_nop 1
  s_cbranch_scc1 L_bail
  s_sleep 1
  s_branch L_spin_23
L_spun_24:
  s_branch L_achk
L_apoll:
  s_mov_b64 exec, s[12:13]
  buffer_load_dwordx4 v[64:67], v18, s[48:51], s22 offen offset:0 sc1
  s_mov_b64 exec, s[14:15]
  buffer_load_dwordx4 v[68:71], v18, s[48:51], s22 offen offset:512 sc1
  s_mov_b64 exec, s[16:17]
  buffer_load_dwordx4 v[72:75], v18, s[48:51], s22 offen offset:1024 sc1
  s_mov_b64 exec, s[18:19]
  buffer_load_dwordx4 v[76:79], v18, s[48:51], s22 offen offset:1536 sc1
  s_mov_b64 exec, -1
  s_cmp_lt_u32 s79, 65
  s_cbranch_scc1 L_ashort
  s_sleep 3
L_ashort:
  s_sleep 1
L_achk:
  s_mov_b64 exec, s[12:13]
  s_cbranch_execz L_ask0
  v_xor_b32 v6, s10, v65
  v_bitop3_b32 v6, v6, v67, s10 bitop3:0xf6
  v_cmp_ne_u32 s[12:13], 0, v6
L_ask0:
  s_mov_b64 exec, s[14:15]
  s_cbranch_execz L_ask1
  v_xor_b32 v6, s10, v69
  v_bitop3_b32 v6, v6, v71, s10 bitop3:0xf6
  v_cmp_ne_u32 s[14:15], 0, v6
L_ask1:
  s_mov_b64 exec, s[16:17]
  s_cbranch_execz L_ask2
  v_xor_b32 v6, s10, v73
  v_bitop3_b32 v6, v6, v75, s10 bitop3:0xf6
  v_cmp_ne_u32 s[16:17], 0, v6
L_ask2:
  s_mov_b64 exec, s[18:19]
  s_cbranch_execz L_ask3
  v_xor_b32 v6, s10, v77
  v_bitop3_b32 v6, v6, v79, s10 bitop3:0xf6
  v_cmp_ne_u32 s[18:19], 0, v6
L_ask3:
  s_bcnt1_i32_b64 s79, s[12:13]
  s_bcnt1_i32_b64 s83, s[14:15]
  s_add_u32 s79, s79, s83
  s_bcnt1_i32_b64 s83, s[16:17]
  s_add_u32 s79, s79, s83
  s_bcnt1_i32_b64 s83, s[18:19]
  s_add_u32 s79, s79, s83
  s_mov_b64 exec, -1
  s_cmp_eq_u32 s79, 0
  s_cbranch_scc1 L_aok
  s_sub_u32 s82, s82, 1
  s_cbranch_scc0 L_apoll
  s_branch L_bail
L_aok:
  v_lshlrev_b32 v96, 16, v64
  v_and_b32 v97, 0xffff0000, v64
  v_lshlrev_b32 v98, 16, v66
  v_and_b32 v99, 0xffff0000, v66
  v_pk_mul_f32 v[36:37], v[96:97], v[232:233] op_sel_hi:[1,0]
  v_pk_mul_f32 v[38:39], v[98:99], v[232:233] op_sel_hi:[1,0]
  v_lshlrev_b32 v100, 16, v68
  v_and_b32 v101, 0xffff0000, v68
  v_lshlrev_b32 v102, 16, v70
  v_and_b32 v103, 0xffff0000, v70
  v_pk_fma_f32 v[36:37], v[100:101], v[232:233], v[36:37] op_sel:[0,1,0] op_sel_hi:[1,1,1]
  v_pk_fma_f32 v[38:39], v[102:103], v[232:233], v[38:39] op_sel:[0,1,0] op_sel_hi:[1,1,1]
  v_lshlrev_b32 v104, 16, v72
  v_and_b32 v105, 0xffff0000, v72
  v_lshlrev_b32 v106, 16, v74
  v_and_b32 v107, 0xffff0000, v74
  v_pk_fma_f32 v[36:37], v[104:105], v[234:235], v[36:37] op_sel:[0,0,0] op_sel_hi:[1,0,1]
  v_pk_fma_f32 v[38:39], v[106:107], v[234:235], v[38:39] op_sel:[0,0,0] op_sel_hi:[1,0,1]
  v_lshlrev_b32 v108, 16, v76
  v_and_b32 v109, 0xffff0000, v76
  v_lshlrev_b32 v110, 16, v78
  v_and_b32 v111, 0xffff0000, v78
  v_pk_fma_f32 v[36:37], v[108:109], v[234:235], v[36:37] op_sel:[0,1,0] op_sel_hi:[1,1,1]
  v_pk_fma_f32 v[38:39], v[110:111], v[234:235], v[38:39] op_sel:[0,1,0] op_sel_hi:[1,1,1]
  v_cvt_pk_bf16_f32 v36, v36, v37
  v_cvt_pk_bf16_f32 v37, v38, v39
  ds_write_b64 v24, v[36:37] offset:9600
  s_mov_b64 exec, 1
  ds_add_u32 v7, v19 offset:68
  s_mov_b64 exec, -1
L_spin_25:
  ds_read_b32 v6, v7 offset:68
  ds_read_b128 v[112:115], v25 offset:9600
  ds_read_b128 v[116:119], v25 offset:9664
  ds_read_b128 v[120:123], v25 offset:9728
  ds_read_b128 v[124:127], v25 offset:9792
  s_waitcnt lgkmcnt(0)
  v_readfirstlane_b32 s3, v6
  s_cmp_eq_u32 s3, 4
  s_cbranch_scc1 L_spun_26
  s_sub_u32 s82, s82, 1
  s_nop 1
  s_cbranch_scc1 L_bail
  s_branch L_spin_25
L_spun_26:
  v_mfma_f32_16x16x32_bf16 v[36:39], v[128:131], v[112:115], 0
  v_mfma_f32_16x16x32_bf16 v[36:39], v[132:135], v[116:119], v[36:39]
  v_mfma_f32_16x16x32_bf16 v[36:39], v[136:139], v[120:123], v[36:39]
  v_mfma_f32_16x16x32_bf16 v[36:39], v[140:143], v[124:127], v[36:39]
  s_nop 6
  s_not_b64 exec, s[80:81]
  v_and_or_b32 v12, v36, v30, s94
  v_and_or_b32 v13, v37, v30, s94
  v_and_or_b32 v14, v38, v30, s94
  v_and_or_b32 v15, v39, v30, s94
  buffer_store_dwordx4 v[12:15], v28, s[48:51], s74 offen sc1
  s_nop 1
  s_branch L_done
L_bail:
  s_load_dwordx2 s[16:17], s[0:1], 80
  s_mov_b64 exec, 1
  v_mov_b32 v8, 1
  v_mov_b32 v9, 0
  s_waitcnt lgkmcnt(0)
  global_atomic_add v9, v8, s[16:17]
L_done:
L_end:
  s_endpgm
.section .rodata,"a"
.p2align 6
.amdhsa_kernel recurrent_scan__sliding_block_cached__glu_gated_glu__decode_kernel
  .amdhsa_next_free_vgpr 256
  .amdhsa_next_free_sgpr 102
  .amdhsa_accum_offset 256
  .amdhsa_group_segment_fixed_size 0
  .amdhsa_kernarg_size 96
  .amdhsa_user_sgpr_count 2
  .amdhsa_user_sgpr_kernarg_segment_ptr 1
  .amdhsa_system_sgpr_workgroup_id_x 1
  .amdhsa_float_denorm_mode_32 3
.end_amdhsa_kernel
```
